```python
import torch

def _softmax(x, axis=-1):
    return torch.softmax(x, dim=axis)
def _gelu(x):
    return torch.nn.functional.gelu(x, approximate="tanh")
def _silu(x):
    return torch.nn.functional.silu(x)
def _sigmoid(x):
    return torch.sigmoid(x)
def _layernorm(x, axis=-1, eps=1e-5):
    m = x.mean(dim=axis, keepdim=True)
    v = x.var(dim=axis, keepdim=True, unbiased=False)
    return (x - m) / torch.sqrt(v + eps)
def _scatter_add(tgt, idx, src, axis=0):
    return tgt.clone().index_add_(axis, idx, src)
def _segment_sum(src, seg, n):
    out = torch.zeros((n,) + src.shape[1:], dtype=src.dtype)
    return out.index_add_(0, seg, src)
def _pad(x, pw):
    flat = tuple(v for pair in reversed(pw) for v in pair)
    return torch.nn.functional.pad(x, flat)

kernel_name = 'sequential_preLN__ssm_conv_s4d__mixer_s_mlp__prompt'

def setup_inputs():

    _w = (lambda a: (lambda t: t.to(torch.bfloat16) if t.is_floating_point() else t)(torch.as_tensor(a)))
    def _A_setup():
        Bsz, L, D, N = 1, 2048, 512, 128
        return {
            "u": _w((lambda *s: torch.randn(*s, dtype=torch.bfloat16) * 0.05)(Bsz, L, D)),
            "log_A_real": _w((lambda *s: torch.randn(*s, dtype=torch.bfloat16) * 6.4)(D, N) * 0.5),
            "A_imag": _w((lambda *s: torch.randn(*s, dtype=torch.bfloat16) * 0.05)(D, N) * 3.14),
            "C_real": _w((lambda *s: torch.randn(*s, dtype=torch.bfloat16) * 0.05)(D, N) / N ** 0.5),
            "C_imag": _w((lambda *s: torch.randn(*s, dtype=torch.bfloat16) * 0.05)(D, N) / N ** 0.5),
            "log_dt": _w((lambda *s: torch.randn(*s, dtype=torch.bfloat16) * 0.05)(D) * 0.5 - 4.0),
            "D_skip": _w((lambda *s: torch.randn(*s, dtype=torch.bfloat16) * 0.05)(D)),
        }
    _A_in = _A_setup()

    def _B_setup():
        B, S, D, F = 1, 2048, 512, 1792
        return {
            "x":  _w((lambda *s: torch.randn(*s, dtype=torch.bfloat16) * 0.05)(B, S, D)),
            "w1": _w((lambda *s: torch.randn(*s, dtype=torch.bfloat16) * 6.4)(D, D) * (D ** -0.5)),
            "w2": _w((lambda *s: torch.randn(*s, dtype=torch.bfloat16) * 6.4)(D, D) * (D ** -0.5)),
            "w3": _w((lambda *s: torch.randn(*s, dtype=torch.bfloat16) * 6.4)(D, F) * (D ** -0.5)),
            "w4": _w((lambda *s: torch.randn(*s, dtype=torch.bfloat16) * 6.4)(F, D) * (F ** -0.5)),
        }
    _B_in = _B_setup()

    return {
        "A_u": _A_in["u"],
        "A_log_A_real": _A_in["log_A_real"],
        "A_A_imag": _A_in["A_imag"],
        "A_C_real": _A_in["C_real"],
        "A_C_imag": _A_in["C_imag"],
        "A_log_dt": _A_in["log_dt"],
        "A_D_skip": _A_in["D_skip"],
        "B_x": _B_in["x"],
        "B_w1": _B_in["w1"],
        "B_w2": _B_in["w2"],
        "B_w3": _B_in["w3"],
        "B_w4": _B_in["w4"],
    }

def reference(A_u, A_log_A_real, A_A_imag, A_C_real, A_C_imag, A_log_dt, A_D_skip, B_x, B_w1, B_w2, B_w3, B_w4):
    def _A_ref(u, log_A_real, A_imag, C_real, C_imag, log_dt, D_skip):
        L = u.shape[1]
        dt = torch.exp(log_dt)
        A = -torch.exp(log_A_real) + 1j * A_imag
        C = (C_real + 1j * C_imag) * dt[:, None]
        pos = (lambda x, dt: x.to(dt))(torch.arange(L), log_dt.dtype)
        P = torch.exp((A * dt[:, None])[:, :, None] * pos[None, None, :])
        K = 2.0 * torch.einsum("dn,dnl->dl", C, P).real
        L2 = 2 * L
        u_t = (lambda x, *d: x.permute(*d))(u, 0, 2, 1)
        Kf = (lambda x, *a, **k: torch.fft.rfft(x.float(), *a, **k))(K, L2)
        Uf = (lambda x, *a, **k: torch.fft.rfft(x.float(), *a, **k))(u_t, L2)
        y = (lambda x, *a, **k: torch.fft.irfft(x, *a, **k).to(torch.bfloat16))(Uf * Kf[None, :, :], L2)[:, :, :L]
        y = (lambda x, *d: x.permute(*d))(y, 0, 2, 1)
        return y + u * D_skip[None, None, :]

    def _B_ref(x, w1, w2, w3, w4):
        B, S, D = x.shape
        h = _gelu(_layernorm(x, axis=-1) @ w1)
        c = D // 4
        g0 = _pad(h[:, :, 0*c:1*c], ((0, 0), (1, 0), (0, 0)))[:, :S, :]
        g1 = _pad(h[:, :, 1*c:2*c], ((0, 0), (0, 1), (0, 0)))[:, 1:, :]
        g2 = _pad(h[:, :, 2*c:3*c], ((0, 0), (2, 0), (0, 0)))[:, :S, :]
        g3 = _pad(h[:, :, 3*c:   ], ((0, 0), (0, 2), (0, 0)))[:, 2:, :]
        hs = torch.concatenate([g0, g1, g2, g3], axis=-1) @ w2
        x1 = x + hs
        h2 = _gelu(_layernorm(x1, axis=-1) @ w3) @ w4
        return x1 + h2

    x = A_u
    h = x + _A_ref(_layernorm(x, axis=-1), A_log_A_real, A_A_imag, A_C_real, A_C_imag, A_log_dt, A_D_skip)
    h2 = h + _B_ref(_layernorm(h, axis=-1), B_w1, B_w2, B_w3, B_w4)
    return h2
```

```asm
; @launch grid=(256,1,1) block=(256,1,1) lds=163840
.amdgcn_target "amdgcn-amd-amdhsa--gfx950"
.text
.globl sequential_preLN__ssm_conv_s4d__mixer_s_mlp__prompt_kernel
.p2align 8
.type sequential_preLN__ssm_conv_s4d__mixer_s_mlp__prompt_kernel,@function
sequential_preLN__ssm_conv_s4d__mixer_s_mlp__prompt_kernel:
  s_cmp_lt_u32 s2, 256
  s_cbranch_scc1 L_go
  s_endpgm
L_go:
  s_load_dwordx16 s[16:31], s[0:1], 0
  s_load_dwordx8 s[32:39], s[0:1], 64
  s_load_dwordx4 s[40:43], s[0:1], 96
  s_load_dwordx2 s[44:45], s[0:1], 112
  v_lshrrev_b32 v3, 6, v0
  v_and_b32 v1, 63, v0
  v_readfirstlane_b32 s3, v3
  v_lshlrev_b32 v2, 4, v1
  v_mov_b32 v7, 0
  s_and_b32 s4, s2, 7
  s_lshr_b32 s5, s2, 3
  s_lshl_b32 s6, s4, 6
  s_lshl_b32 s7, s5, 1
  s_add_u32 s70, s6, s7
  s_lshl_b32 s6, s4, 3
  s_lshr_b32 s7, s5, 2
  s_add_u32 s71, s6, s7
  s_and_b32 s72, s5, 3
  s_lshl_b32 s6, s4, 1
  s_lshr_b32 s7, s5, 4
  s_add_u32 s73, s6, s7
  s_and_b32 s74, s5, 15
  s_lshl_b32 s6, s4, 2
  s_lshr_b32 s7, s5, 3
  s_add_u32 s75, s6, s7
  s_and_b32 s76, s5, 7
  s_mov_b32 s68, 0x3f803f80
  s_mov_b32 s69, 0xffff0000
  s_lshl_b32 s6, s2, 2
  s_add_u32 s6, s6, s3
  s_and_b32 s7, s6, 511
  s_lshr_b32 s8, s7, 4
  s_and_b32 s9, s7, 15
  s_lshl_b32 s10, s8, 14
  s_lshl_b32 s11, s9, 6
  s_add_u32 s88, s10, s11
  s_lshl_b32 s10, s9, 5
  s_add_u32 s10, s10, s8
  s_lshl_b32 s10, s10, 10
  s_lshr_b32 s11, s6, 9
  s_lshl_b32 s11, s11, 19
  s_add_u32 s10, s10, s11
  s_add_u32 s96, s10, 16777216
  s_mov_b32 s7, s6
  s_mul_i32 s8, s7, 4682
  s_lshr_b32 s8, s8, 18
  s_mul_i32 s9, s8, 56
  s_sub_u32 s9, s7, s9
  s_mul_i32 s10, s8, 57344
  s_lshl_b32 s11, s9, 6
  s_add_u32 s89, s10, s11
  s_lshl_b32 s10, s9, 5
  s_add_u32 s10, s10, s8
  s_lshl_b32 s10, s10, 10
  s_add_u32 s97, s10, 17825792
  s_add_u32 s7, s6, 1024
  s_cmp_lt_u32 s6, 768
  s_cselect_b32 s7, s7, s6
  s_mul_i32 s8, s7, 4682
  s_lshr_b32 s8, s8, 18
  s_mul_i32 s9, s8, 56
  s_sub_u32 s9, s7, s9
  s_mul_i32 s10, s8, 57344
  s_lshl_b32 s11, s9, 6
  s_add_u32 s90, s10, s11
  s_lshl_b32 s10, s9, 5
  s_add_u32 s10, s10, s8
  s_lshl_b32 s10, s10, 10
  s_add_u32 s98, s10, 17825792
  s_mov_b32 s7, s6
  s_lshr_b32 s8, s7, 4
  s_and_b32 s9, s7, 15
  s_lshl_b32 s10, s8, 14
  s_lshl_b32 s11, s9, 6
  s_add_u32 s91, s10, s11
  s_mul_i32 s10, s9, 112
  s_add_u32 s10, s10, s8
  s_lshl_b32 s10, s10, 10
  s_add_u32 s99, s10, 19922944
  s_add_u32 s7, s6, 768
  s_cmp_ge_u32 s6, 256
  s_cselect_b32 s7, s7, s6
  s_lshr_b32 s8, s7, 4
  s_and_b32 s9, s7, 15
  s_lshl_b32 s10, s8, 14
  s_lshl_b32 s11, s9, 6
  s_add_u32 s92, s10, s11
  s_mul_i32 s10, s9, 112
  s_add_u32 s10, s10, s8
  s_lshl_b32 s10, s10, 10
  s_add_u32 s100, s10, 19922944
  v_lshrrev_b32 v4, 2, v1
  v_and_b32 v5, 3, v1
  v_lshlrev_b32 v5, 4, v5
  v_lshl_add_u32 v14, v4, 10, v5
  v_mul_u32_u24 v15, 3584, v4
  v_add_u32 v15, v15, v5
  v_mov_b32 v44, 0
  v_mov_b32 v45, 0
  v_mov_b32 v46, 0
  v_mov_b32 v47, 0
  v_lshrrev_b32 v4, 5, v1
  v_lshlrev_b32 v3, 8, v4
  v_bfe_u32 v4, v1, 2, 2
  v_lshl_add_u32 v3, v4, 6, v3
  v_bfe_u32 v4, v1, 4, 1
  v_lshl_add_u32 v3, v4, 5, v3
  v_and_b32 v4, 3, v1
  v_lshl_add_u32 v3, v4, 3, v3
  s_waitcnt lgkmcnt(0)
  s_mov_b32 s48, s44
  s_mov_b32 s49, s45
  s_mov_b32 s50, 33554432
  s_mov_b32 s51, 0x20000
  s_mov_b32 s52, s16
  s_mov_b32 s53, s17
  s_mov_b32 s54, 2097152
  s_mov_b32 s55, 0x20000
  s_mov_b32 s56, s40
  s_mov_b32 s57, s41
  s_mov_b32 s58, 2097152
  s_mov_b32 s59, 0x20000
  s_mov_b32 s64, s42
  s_mov_b32 s65, s43
  s_mov_b32 s66, 256
  s_mov_b32 s67, 0x20000
  s_mov_b32 s80, s36
  s_mov_b32 s81, s37
  s_mov_b32 s82, 1835008
  s_mov_b32 s83, 0x20000
  s_mov_b32 s84, s38
  s_mov_b32 s85, s39
  s_mov_b32 s86, 1835008
  s_mov_b32 s87, 0x20000
  s_cmp_lt_u32 s6, 512
  s_cselect_b32 s60, s32, s34
  s_cselect_b32 s61, s33, s35
  s_mov_b32 s62, 524288
  s_mov_b32 s63, 0x20000
  s_lshl_b32 s7, s70, 1
  s_load_dword s78, s[28:29], s7
  s_load_dword s79, s[26:27], s7
  s_or_b32 s8, s2, s3
  s_cbranch_scc1 L_nz
  v_lshlrev_b32 v4, 7, v1
  s_mov_b32 s8, 131072
  buffer_store_dwordx4 v[44:47], v4, s[48:51], s8 offen sc1
  buffer_load_dword v12, off, s[64:67], 0
L_nz:
  s_lshl_b32 s9, s70, 8
  v_lshlrev_b32 v4, 1, v0
  v_add_u32 v4, s9, v4
  v_xor_b32 v5, 128, v4
  global_load_ushort v48, v4, s[18:19]
  global_load_ushort v49, v4, s[20:21]
  global_load_ushort v50, v4, s[22:23]
  global_load_ushort v51, v4, s[24:25]
  global_load_ushort v52, v5, s[22:23]
  global_load_ushort v53, v5, s[24:25]
  s_lshl_b32 s8, s71, 2
  s_add_u32 s47, s8, s72
  s_lshl_b32 s8, s47, 13
  s_lshl_b32 s9, s3, 11
  s_add_u32 s8, s8, s9
  buffer_load_dwordx4 v[96:99], v2, s[52:55], s8 offen
  buffer_load_dwordx4 v[100:103], v2, s[52:55], s8 offen offset:1024
  s_lshl_b32 s10, s71, 15
  s_lshl_b32 s11, s72, 8
  s_add_u32 s10, s10, s11
  s_lshl_b32 s11, s3, 6
  s_add_u32 s10, s10, s11
  s_mul_i32 s11, s3, 4160
  s_mov_b32 m0, s11
  s_add_u32 s12, s10, 16384
  buffer_load_dwordx4 v14, s[52:55], s10 offen lds
  s_add_u32 m0, s11, 1024
  s_nop 0
  buffer_load_dwordx4 v14, s[52:55], s12 offen lds
  s_add_u32 m0, s11, 2048
  s_nop 0
  buffer_load_dwordx4 v14, s[60:63], s88 offen lds
  v_add_u32 v13, s11, v3
  s_and_b32 s9, s3, 1
  s_mul_i32 s12, s9, 33792
  s_add_u32 s12, s12, 93536
  s_mul_i32 s9, s9, 7680
  s_add_u32 s9, s9, 69040
  s_cmp_lt_u32 s3, 2
  s_cselect_b32 s77, s12, s9
  v_and_b32 v8, 3, v1
  v_lshlrev_b32 v8, 9, v8
  v_bfe_u32 v9, v1, 2, 2
  v_lshl_add_u32 v8, v9, 6, v8
  v_lshrrev_b32 v9, 4, v1
  v_lshl_add_u32 v8, v9, 3, v8
  v_add_u32 v8, s11, v8
  v_lshlrev_b32 v9, 14, v9
  v_and_b32 v10, 15, v1
  v_lshl_add_u32 v9, v10, 4, v9
  s_lshl_b32 s10, s72, 19
  s_lshl_b32 s11, s3, 17
  s_add_u32 s10, s10, s11
  s_lshl_b32 s11, s71, 8
  s_add_u32 s10, s10, s11
  s_add_u32 s101, s10, 22020096
  s_add_u32 s93, s101, 65536
  s_lshl_b32 s10, s2, 7
  s_mov_b64 exec, 1
  buffer_store_dwordx2 v[44:45], off, s[48:51], s10 sc1
  s_mov_b64 exec, -1
  buffer_load_dword v11, off, s[64:67], 0
  v_lshlrev_b32 v4, 4, v0
  v_add_u32 v4, 66560, v4
  v_cmp_gt_u32 vcc, 155, v0
  s_and_saveexec_b64 s[10:11], vcc
  s_cbranch_execz L_z1
  ds_write_b128 v4, v[44:47]
  ds_write_b128 v4, v[44:47] offset:7680
L_z1:
  s_mov_b64 exec, -1
  v_mul_u32_u24 v4, 86, v0
  v_lshrrev_b32 v4, 8, v4
  v_mul_u32_u24 v5, 3, v4
  v_sub_u32 v5, v0, v5
  v_mul_u32_u24 v4, 4160, v4
  v_lshl_add_u32 v4, v5, 4, v4
  v_cmp_gt_u32 vcc, 48, v0
  s_and_saveexec_b64 s[10:11], vcc
  s_cbranch_execz L_z2
  ds_write_b128 v4, v[44:47] offset:4096
L_z2:
  s_mov_b64 exec, -1
  v_lshlrev_b32 v4, 1, v0
  v_sub_u32 v4, 2047, v4
  v_subrev_u32 v5, 1, v4
  v_cvt_f32_u32 v4, v4
  v_cvt_f32_u32 v5, v5
  v_cvt_pk_bf16_f32 v4, v4, v5
  v_and_b32 v5, s69, v4
  v_lshlrev_b32 v4, 16, v4
  v_cvt_u32_f32 v4, v4
  v_cvt_u32_f32 v5, v5
  v_mov_b32 v6, 149504
  v_lshl_add_u32 v16, v4, 1, v6
  v_lshl_add_u32 v17, v5, 1, v6
  v_lshlrev_b32 v4, 1, v0
  v_sub_u32 v4, 1535, v4
  v_subrev_u32 v5, 1, v4
  v_cvt_f32_u32 v4, v4
  v_cvt_f32_u32 v5, v5
  v_cvt_pk_bf16_f32 v4, v4, v5
  v_and_b32 v5, s69, v4
  v_lshlrev_b32 v4, 16, v4
  v_cvt_u32_f32 v4, v4
  v_cvt_u32_f32 v5, v5
  v_mov_b32 v6, 149504
  v_lshl_add_u32 v18, v4, 1, v6
  v_lshl_add_u32 v19, v5, 1, v6
  v_lshlrev_b32 v4, 1, v0
  v_sub_u32 v4, 1023, v4
  v_subrev_u32 v5, 1, v4
  v_cvt_f32_u32 v4, v4
  v_cvt_f32_u32 v5, v5
  v_cvt_pk_bf16_f32 v4, v4, v5
  v_and_b32 v5, s69, v4
  v_lshlrev_b32 v4, 16, v4
  v_cvt_u32_f32 v4, v4
  v_cvt_u32_f32 v5, v5
  v_mov_b32 v6, 149504
  v_lshl_add_u32 v20, v4, 1, v6
  v_lshl_add_u32 v21, v5, 1, v6
  v_lshlrev_b32 v4, 1, v0
  v_sub_u32 v4, 511, v4
  v_subrev_u32 v5, 1, v4
  v_cvt_f32_u32 v4, v4
  v_cvt_f32_u32 v5, v5
  v_cvt_pk_bf16_f32 v4, v4, v5
  v_and_b32 v5, s69, v4
  v_lshlrev_b32 v4, 16, v4
  v_cvt_u32_f32 v4, v4
  v_cvt_u32_f32 v5, v5
  v_mov_b32 v6, 149504
  v_lshl_add_u32 v22, v4, 1, v6
  v_lshl_add_u32 v23, v5, 1, v6
  s_or_b32 s14, s2, s3
  s_cbranch_scc1 L_ng
  v_mov_b32 v110, 1
  s_mov_b64 exec, 1
  s_waitcnt vmcnt(13)
  buffer_store_dword v110, off, s[64:67], 0 offset:252 sc1
  s_mov_b64 exec, -1
L_ng:
  s_waitcnt vmcnt(7) lgkmcnt(0)
  v_lshlrev_b32 v48, 16, v48
  v_lshlrev_b32 v49, 16, v49
  v_lshlrev_b32 v50, 16, v50
  v_lshlrev_b32 v51, 16, v51
  v_lshlrev_b32 v52, 16, v52
  v_lshlrev_b32 v53, 16, v53
  s_lshl_b32 s8, s79, 16
  s_and_b32 s9, s79, s69
  s_cmp_lt_u32 s3, 2
  s_cselect_b32 s8, s8, s9
  v_mov_b32 v54, 0x3fb8aa3b
  v_mul_f32 v54, s8, v54
  v_mul_f32 v48, 0x3fb8aa3b, v48
  v_exp_f32 v54, v54
  v_exp_f32 v48, v48
  v_max3_f32 v57, |v50|, |v51|, |v52|
  v_max_f32 v57, v57, |v53|
  v_cvt_pk_bf16_f32 v54, v54, v48
  v_and_b32 v48, s69, v54
  v_lshlrev_b32 v54, 16, v54
  v_max_f32_dpp v57, v57, v57 row_shr:1 row_mask:0xf bank_mask:0xf bound_ctrl:0
s_nop 1
  v_max_f32_dpp v57, v57, v57 row_shr:2 row_mask:0xf bank_mask:0xf bound_ctrl:0
s_nop 1
  v_max_f32_dpp v57, v57, v57 row_shr:4 row_mask:0xf bank_mask:0xf bound_ctrl:0
s_nop 1
  v_max_f32_dpp v57, v57, v57 row_shr:8 row_mask:0xf bank_mask:0xf bound_ctrl:0
s_nop 1
  v_max_f32_dpp v57, v57, v57 row_bcast:15 row_mask:0xa bank_mask:0xf
s_nop 1
  v_max_f32_dpp v57, v57, v57 row_bcast:31 row_mask:0xc bank_mask:0xf
  v_mul_f32 v55, -v48, v54
  v_mul_f32 v56, v49, v54
  v_mul_f32 v55, 0x3fb8aa3b, v55
  v_mul_f32 v56, 0x3e22f983, v56
  v_mul_f32 v57, v57, v54
  v_add_f32 v57, v57, v57
s_nop 0
  v_readlane_b32 s8, v57, 63
  s_bfe_u32 s8, s8, 0x80017
  s_sub_u32 s8, 259, s8
  s_min_u32 s8, s8, 253
  s_max_u32 s8, s8, 1
  s_sub_u32 s9, 254, s8
  s_lshl_b32 s9, s9, 23
  s_add_u32 s8, s8, 1
  s_lshl_b32 s8, s8, 23
  v_exp_f32 v24, v55
  v_fract_f32 v25, v56
  v_cos_f32 v26, v25
  v_sin_f32 v27, v25
  v_mul_f32 v58, v24, v26
  v_mul_f32 v59, v24, v27
  v_mul_f32 v24, 0x41000000, v55
  v_mul_f32 v25, 0x41000000, v56
  v_exp_f32 v24, v24
  v_fract_f32 v25, v25
  v_cos_f32 v26, v25
  v_sin_f32 v27, v25
  v_mul_f32 v60, v24, v26
  v_mul_f32 v61, v24, v27
  v_mul_f32 v24, 0x43800000, v55
  v_mul_f32 v25, 0x43800000, v56
  v_exp_f32 v24, v24
  v_fract_f32 v25, v25
  v_cos_f32 v26, v25
  v_sin_f32 v27, v25
  v_mul_f32 v62, v24, v26
  v_mul_f32 v63, v24, v27
  v_lshrrev_b32 v5, 7, v0
  v_lshlrev_b32 v6, 2, v5
  v_add_u32 v6, 160256, v6
  v_mov_b32 v24, s9
  ds_write_b32 v6, v24
  s_mov_b32 s10, 81920
  v_and_b32 v4, 127, v0
  v_lshlrev_b32 v4, 2, v4
  v_mul_u32_u24 v5, 33792, v5
  v_add3_u32 v4, v4, v5, s10
  v_mul_f32 v50, v50, v54
  v_mul_f32 v51, v51, v54
  v_mul_f32 v24, s8, v50
  v_mul_f32 v25, s8, v51
  v_mov_b32 v48, 0x3c00
  v_cvt_pk_f16_f32 v40, v24, -v25
  ds_write_b32 v4, v48 offset:16896
  ds_write_b32 v4, v40 offset:0
  v_cvt_pk_f16_f32 v49, v60, v61
  v_pk_mul_f32 v[38:39], v[24:25], v[58:59] op_sel:[0,0] op_sel_hi:[1,0]
  ds_write_b32 v4, v49 offset:17424
  v_pk_mul_f32 v[46:47], v[60:61], v[60:61] op_sel:[0,0] op_sel_hi:[1,0]
  v_pk_fma_f32 v[32:33], v[24:25], v[58:59], v[38:39] op_sel:[1,1,0] op_sel_hi:[0,1,1] neg_lo:[1,0,0]
  v_pk_fma_f32 v[42:43], v[60:61], v[60:61], v[46:47] op_sel:[1,1,0] op_sel_hi:[0,1,1] neg_lo:[1,0,0]
  v_cvt_pk_f16_f32 v41, v32, -v33
  v_cvt_pk_f16_f32 v48, v42, v43
  ds_write_b32 v4, v48 offset:17952
  ds_write_b32 v4, v41 offset:528
  v_pk_mul_f32 v[46:47], v[42:43], v[60:61] op_sel:[0,0] op_sel_hi:[1,0]
  v_pk_mul_f32 v[38:39], v[32:33], v[58:59] op_sel:[0,0] op_sel_hi:[1,0]
  v_pk_fma_f32 v[44:45], v[42:43], v[60:61], v[46:47] op_sel:[1,1,0] op_sel_hi:[0,1,1] neg_lo:[1,0,0]
  v_cvt_pk_f16_f32 v49, v44, v45
  v_pk_fma_f32 v[26:27], v[32:33], v[58:59], v[38:39] op_sel:[1,1,0] op_sel_hi:[0,1,1] neg_lo:[1,0,0]
  ds_write_b32 v4, v49 offset:18480
  v_cvt_pk_f16_f32 v40, v26, -v27
  v_pk_mul_f32 v[46:47], v[44:45], v[60:61] op_sel:[0,0] op_sel_hi:[1,0]
  v_pk_fma_f32 v[42:43], v[44:45], v[60:61], v[46:47] op_sel:[1,1,0] op_sel_hi:[0,1,1] neg_lo:[1,0,0]
  ds_write_b32 v4, v40 offset:1056
  v_cvt_pk_f16_f32 v48, v42, v43
  v_pk_mul_f32 v[38:39], v[26:27], v[58:59] op_sel:[0,0] op_sel_hi:[1,0]
  ds_write_b32 v4, v48 offset:19008
  v_pk_mul_f32 v[46:47], v[42:43], v[60:61] op_sel:[0,0] op_sel_hi:[1,0]
  v_pk_fma_f32 v[32:33], v[26:27], v[58:59], v[38:39] op_sel:[1,1,0] op_sel_hi:[0,1,1] neg_lo:[1,0,0]
  v_pk_fma_f32 v[44:45], v[42:43], v[60:61], v[46:47] op_sel:[1,1,0] op_sel_hi:[0,1,1] neg_lo:[1,0,0]
  v_cvt_pk_f16_f32 v41, v32, -v33
  v_cvt_pk_f16_f32 v49, v44, v45
  ds_write_b32 v4, v49 offset:19536
  ds_write_b32 v4, v41 offset:1584
  v_pk_mul_f32 v[46:47], v[44:45], v[60:61] op_sel:[0,0] op_sel_hi:[1,0]
  v_pk_mul_f32 v[38:39], v[32:33], v[58:59] op_sel:[0,0] op_sel_hi:[1,0]
  v_pk_fma_f32 v[42:43], v[44:45], v[60:61], v[46:47] op_sel:[1,1,0] op_sel_hi:[0,1,1] neg_lo:[1,0,0]
  v_cvt_pk_f16_f32 v48, v42, v43
  v_pk_fma_f32 v[28:29], v[32:33], v[58:59], v[38:39] op_sel:[1,1,0] op_sel_hi:[0,1,1] neg_lo:[1,0,0]
  ds_write_b32 v4, v48 offset:20064
  v_cvt_pk_f16_f32 v40, v28, -v29
  v_pk_mul_f32 v[46:47], v[42:43], v[60:61] op_sel:[0,0] op_sel_hi:[1,0]
  v_pk_fma_f32 v[44:45], v[42:43], v[60:61], v[46:47] op_sel:[1,1,0] op_sel_hi:[0,1,1] neg_lo:[1,0,0]
  ds_write_b32 v4, v40 offset:2112
  v_cvt_pk_f16_f32 v49, v44, v45
  v_pk_mul_f32 v[38:39], v[28:29], v[58:59] op_sel:[0,0] op_sel_hi:[1,0]
  ds_write_b32 v4, v49 offset:20592
  v_pk_mul_f32 v[46:47], v[44:45], v[60:61] op_sel:[0,0] op_sel_hi:[1,0]
  v_pk_fma_f32 v[32:33], v[28:29], v[58:59], v[38:39] op_sel:[1,1,0] op_sel_hi:[0,1,1] neg_lo:[1,0,0]
  v_pk_fma_f32 v[42:43], v[44:45], v[60:61], v[46:47] op_sel:[1,1,0] op_sel_hi:[0,1,1] neg_lo:[1,0,0]
  v_cvt_pk_f16_f32 v41, v32, -v33
  v_cvt_pk_f16_f32 v48, v42, v43
  ds_write_b32 v4, v41 offset:2640
  s_waitcnt vmcnt(5)
  v_dot2_f32_bf16 v104, v96, s68, 0
  v_dot2_f32_bf16 v106, v96, v96, 0
  v_dot2_f32_bf16 v105, v100, s68, 0
  v_dot2_f32_bf16 v107, v100, v100, 0
  v_dot2_f32_bf16 v104, v97, s68, v104
  v_dot2_f32_bf16 v106, v97, v97, v106
  v_dot2_f32_bf16 v105, v101, s68, v105
  v_dot2_f32_bf16 v107, v101, v101, v107
  v_dot2_f32_bf16 v104, v98, s68, v104
  v_dot2_f32_bf16 v106, v98, v98, v106
  v_dot2_f32_bf16 v105, v102, s68, v105
  v_dot2_f32_bf16 v107, v102, v102, v107
  v_dot2_f32_bf16 v104, v99, s68, v104
  v_dot2_f32_bf16 v106, v99, v99, v106
  v_dot2_f32_bf16 v105, v103, s68, v105
  v_dot2_f32_bf16 v107, v103, v103, v107
  v_add_f32_dpp v104, v104, v104 row_shr:1 row_mask:0xf bank_mask:0xf bound_ctrl:0
s_nop 0
  v_add_f32_dpp v105, v105, v105 row_shr:1 row_mask:0xf bank_mask:0xf bound_ctrl:0
  v_add_f32_dpp v106, v106, v106 row_shr:1 row_mask:0xf bank_mask:0xf bound_ctrl:0
  v_add_f32_dpp v107, v107, v107 row_shr:1 row_mask:0xf bank_mask:0xf bound_ctrl:0
  v_add_f32_dpp v104, v104, v104 row_shr:2 row_mask:0xf bank_mask:0xf bound_ctrl:0
  v_add_f32_dpp v105, v105, v105 row_shr:2 row_mask:0xf bank_mask:0xf bound_ctrl:0
  v_add_f32_dpp v106, v106, v106 row_shr:2 row_mask:0xf bank_mask:0xf bound_ctrl:0
  v_add_f32_dpp v107, v107, v107 row_shr:2 row_mask:0xf bank_mask:0xf bound_ctrl:0
  v_add_f32_dpp v104, v104, v104 row_shr:4 row_mask:0xf bank_mask:0xf bound_ctrl:0
  v_add_f32_dpp v105, v105, v105 row_shr:4 row_mask:0xf bank_mask:0xf bound_ctrl:0
  v_add_f32_dpp v106, v106, v106 row_shr:4 row_mask:0xf bank_mask:0xf bound_ctrl:0
  v_add_f32_dpp v107, v107, v107 row_shr:4 row_mask:0xf bank_mask:0xf bound_ctrl:0
  v_add_f32_dpp v104, v104, v104 row_shr:8 row_mask:0xf bank_mask:0xf bound_ctrl:0
  v_add_f32_dpp v105, v105, v105 row_shr:8 row_mask:0xf bank_mask:0xf bound_ctrl:0
  v_add_f32_dpp v106, v106, v106 row_shr:8 row_mask:0xf bank_mask:0xf bound_ctrl:0
  v_add_f32_dpp v107, v107, v107 row_shr:8 row_mask:0xf bank_mask:0xf bound_ctrl:0
  v_add_f32_dpp v104, v104, v104 row_bcast:15 row_mask:0xa bank_mask:0xf
  v_add_f32_dpp v105, v105, v105 row_bcast:15 row_mask:0xa bank_mask:0xf
  v_add_f32_dpp v106, v106, v106 row_bcast:15 row_mask:0xa bank_mask:0xf
  v_add_f32_dpp v107, v107, v107 row_bcast:15 row_mask:0xa bank_mask:0xf
  v_add_f32_dpp v104, v104, v104 row_bcast:31 row_mask:0xc bank_mask:0xf
  v_add_f32_dpp v105, v105, v105 row_bcast:31 row_mask:0xc bank_mask:0xf
  v_add_f32_dpp v106, v106, v106 row_bcast:31 row_mask:0xc bank_mask:0xf
  v_add_f32_dpp v107, v107, v107 row_bcast:31 row_mask:0xc bank_mask:0xf
  v_mul_f32 v104, 0x3b000000, v104
  v_mul_f32 v106, 0x3b000000, v106
  v_fma_f32 v106, -v104, v104, v106
  v_max_f32 v106, 0, v106
  v_cvt_pk_bf16_f32 v108, v104, v106
  v_and_b32 v108, s69, v108
  v_add_f32 v108, 0x3727c5ac, v108
  v_cvt_pk_bf16_f32 v108, v108, v108
  v_lshlrev_b32 v108, 16, v108
  v_sqrt_f32 v108, v108
s_nop 0
  v_cvt_pk_bf16_f32 v108, v104, v108
  v_mul_f32 v105, 0x3b000000, v105
  v_mul_f32 v107, 0x3b000000, v107
  v_fma_f32 v107, -v105, v105, v107
  v_max_f32 v107, 0, v107
  v_cvt_pk_bf16_f32 v109, v105, v107
  v_and_b32 v109, s69, v109
  v_add_f32 v109, 0x3727c5ac, v109
  v_cvt_pk_bf16_f32 v109, v109, v109
  v_lshlrev_b32 v109, 16, v109
  v_sqrt_f32 v109, v109
s_nop 0
  v_cvt_pk_bf16_f32 v109, v105, v109
  s_lshl_b32 s14, s47, 5
  s_lshl_b32 s15, s3, 3
  s_add_u32 s14, s14, s15
  s_add_u32 s14, s14, 36864
  s_mov_b32 exec_lo, 0
  s_mov_b32 exec_hi, 0x80000000
  buffer_store_dwordx2 v[108:109], off, s[48:51], s14 sc1
  s_mov_b64 exec, -1
  s_waitcnt vmcnt(4)
  ds_read_b64_tr_b16 v[84:85], v8 offset:0
  ds_read_b64_tr_b16 v[86:87], v8 offset:256
  ds_read_b64_tr_b16 v[88:89], v8 offset:32
  ds_read_b64_tr_b16 v[90:91], v8 offset:288
  s_waitcnt lgkmcnt(2)
  buffer_store_dwordx4 v[84:87], v9, s[48:51], s101 offen sc1
  s_waitcnt lgkmcnt(0)
  buffer_store_dwordx4 v[88:91], v9, s[48:51], s93 offen sc1
  s_waitcnt vmcnt(5)
  ds_read_b64_tr_b16 v[64:65], v13 offset:2048
  ds_read_b64_tr_b16 v[66:67], v13 offset:2560
  s_waitcnt lgkmcnt(0)
  buffer_store_dwordx4 v[64:67], v2, s[48:51], s96 offen sc1
  buffer_load_dword v12, off, s[64:67], 0 offset:252 sc1
  ds_write_b32 v4, v48 offset:21120
  v_pk_mul_f32 v[46:47], v[42:43], v[60:61] op_sel:[0,0] op_sel_hi:[1,0]
  v_pk_mul_f32 v[38:39], v[32:33], v[58:59] op_sel:[0,0] op_sel_hi:[1,0]
  v_pk_fma_f32 v[44:45], v[42:43], v[60:61], v[46:47] op_sel:[1,1,0] op_sel_hi:[0,1,1] neg_lo:[1,0,0]
  v_pk_fma_f32 v[30:31], v[32:33], v[58:59], v[38:39] op_sel:[1,1,0] op_sel_hi:[0,1,1] neg_lo:[1,0,0]
  v_cvt_pk_f16_f32 v49, v44, v45
  ds_write_b32 v4, v49 offset:21648
  v_cvt_pk_f16_f32 v40, v30, -v31
  v_pk_mul_f32 v[46:47], v[44:45], v[60:61] op_sel:[0,0] op_sel_hi:[1,0]
  ds_write_b32 v4, v40 offset:3168
  v_pk_fma_f32 v[42:43], v[44:45], v[60:61], v[46:47] op_sel:[1,1,0] op_sel_hi:[0,1,1] neg_lo:[1,0,0]
  v_cvt_pk_f16_f32 v48, v42, v43
  v_pk_mul_f32 v[38:39], v[30:31], v[58:59] op_sel:[0,0] op_sel_hi:[1,0]
  ds_write_b32 v4, v48 offset:22176
  v_pk_fma_f32 v[32:33], v[30:31], v[58:59], v[38:39] op_sel:[1,1,0] op_sel_hi:[0,1,1] neg_lo:[1,0,0]
  v_pk_mul_f32 v[46:47], v[42:43], v[60:61] op_sel:[0,0] op_sel_hi:[1,0]
  v_pk_fma_f32 v[44:45], v[42:43], v[60:61], v[46:47] op_sel:[1,1,0] op_sel_hi:[0,1,1] neg_lo:[1,0,0]
  v_cvt_pk_f16_f32 v41, v32, -v33
  v_cvt_pk_f16_f32 v49, v44, v45
  ds_write_b32 v4, v41 offset:3696
  ds_write_b32 v4, v49 offset:22704
  v_pk_mul_f32 v[46:47], v[44:45], v[60:61] op_sel:[0,0] op_sel_hi:[1,0]
  v_pk_mul_f32 v[38:39], v[24:25], v[62:63] op_sel:[0,0] op_sel_hi:[1,0]
  v_pk_fma_f32 v[42:43], v[44:45], v[60:61], v[46:47] op_sel:[1,1,0] op_sel_hi:[0,1,1] neg_lo:[1,0,0]
  v_pk_fma_f32 v[34:35], v[24:25], v[62:63], v[38:39] op_sel:[1,1,0] op_sel_hi:[0,1,1] neg_lo:[1,0,0]
  v_cvt_pk_f16_f32 v48, v42, v43
  ds_write_b32 v4, v48 offset:23232
  v_cvt_pk_f16_f32 v40, v34, -v35
  v_pk_mul_f32 v[46:47], v[42:43], v[60:61] op_sel:[0,0] op_sel_hi:[1,0]
  ds_write_b32 v4, v40 offset:4224
  v_pk_fma_f32 v[44:45], v[42:43], v[60:61], v[46:47] op_sel:[1,1,0] op_sel_hi:[0,1,1] neg_lo:[1,0,0]
  v_cvt_pk_f16_f32 v49, v44, v45
  v_pk_mul_f32 v[38:39], v[26:27], v[62:63] op_sel:[0,0] op_sel_hi:[1,0]
  ds_write_b32 v4, v49 offset:23760
  v_pk_fma_f32 v[24:25], v[26:27], v[62:63], v[38:39] op_sel:[1,1,0] op_sel_hi:[0,1,1] neg_lo:[1,0,0]
  v_pk_mul_f32 v[46:47], v[44:45], v[60:61] op_sel:[0,0] op_sel_hi:[1,0]
  v_pk_fma_f32 v[42:43], v[44:45], v[60:61], v[46:47] op_sel:[1,1,0] op_sel_hi:[0,1,1] neg_lo:[1,0,0]
  v_cvt_pk_f16_f32 v41, v24, -v25
  v_cvt_pk_f16_f32 v48, v42, v43
  ds_write_b32 v4, v41 offset:6336
  ds_write_b32 v4, v48 offset:24288
  v_pk_mul_f32 v[46:47], v[42:43], v[60:61] op_sel:[0,0] op_sel_hi:[1,0]
  v_pk_mul_f32 v[38:39], v[28:29], v[62:63] op_sel:[0,0] op_sel_hi:[1,0]
  v_pk_fma_f32 v[44:45], v[42:43], v[60:61], v[46:47] op_sel:[1,1,0] op_sel_hi:[0,1,1] neg_lo:[1,0,0]
  v_pk_fma_f32 v[24:25], v[28:29], v[62:63], v[38:39] op_sel:[1,1,0] op_sel_hi:[0,1,1] neg_lo:[1,0,0]
  v_cvt_pk_f16_f32 v49, v44, v45
  ds_write_b32 v4, v49 offset:24816
  v_cvt_pk_f16_f32 v40, v24, -v25
  v_pk_mul_f32 v[46:47], v[44:45], v[60:61] op_sel:[0,0] op_sel_hi:[1,0]
  ds_write_b32 v4, v40 offset:4752
  v_pk_fma_f32 v[42:43], v[44:45], v[60:61], v[46:47] op_sel:[1,1,0] op_sel_hi:[0,1,1] neg_lo:[1,0,0]
  v_mov_b32 v28, v24
  v_cvt_pk_f16_f32 v48, v42, v43
  ds_write_b32 v4, v48 offset:25344
  v_mov_b32 v29, v25
  v_pk_mul_f32 v[46:47], v[42:43], v[60:61] op_sel:[0,0] op_sel_hi:[1,0]
  v_pk_mul_f32 v[38:39], v[30:31], v[62:63] op_sel:[0,0] op_sel_hi:[1,0]
  v_pk_fma_f32 v[44:45], v[42:43], v[60:61], v[46:47] op_sel:[1,1,0] op_sel_hi:[0,1,1] neg_lo:[1,0,0]
  v_cvt_pk_f16_f32 v49, v44, v45
  v_pk_fma_f32 v[24:25], v[30:31], v[62:63], v[38:39] op_sel:[1,1,0] op_sel_hi:[0,1,1] neg_lo:[1,0,0]
  ds_write_b32 v4, v49 offset:25872
  v_cvt_pk_f16_f32 v41, v24, -v25
  v_pk_mul_f32 v[46:47], v[44:45], v[60:61] op_sel:[0,0] op_sel_hi:[1,0]
  v_pk_fma_f32 v[42:43], v[44:45], v[60:61], v[46:47] op_sel:[1,1,0] op_sel_hi:[0,1,1] neg_lo:[1,0,0]
  ds_write_b32 v4, v41 offset:6864
  v_cvt_pk_f16_f32 v48, v42, v43
  v_pk_mul_f32 v[38:39], v[34:35], v[62:63] op_sel:[0,0] op_sel_hi:[1,0]
  ds_write_b32 v4, v48 offset:26400
  v_pk_mul_f32 v[46:47], v[42:43], v[60:61] op_sel:[0,0] op_sel_hi:[1,0]
  v_pk_fma_f32 v[36:37], v[34:35], v[62:63], v[38:39] op_sel:[1,1,0] op_sel_hi:[0,1,1] neg_lo:[1,0,0]
  v_pk_fma_f32 v[44:45], v[42:43], v[60:61], v[46:47] op_sel:[1,1,0] op_sel_hi:[0,1,1] neg_lo:[1,0,0]
  v_cvt_pk_f16_f32 v40, v36, -v37
  v_cvt_pk_f16_f32 v49, v44, v45
  ds_write_b32 v4, v49 offset:26928
  ds_write_b32 v4, v40 offset:5280
  v_pk_mul_f32 v[46:47], v[44:45], v[60:61] op_sel:[0,0] op_sel_hi:[1,0]
  v_pk_mul_f32 v[38:39], v[28:29], v[62:63] op_sel:[0,0] op_sel_hi:[1,0]
  v_pk_fma_f32 v[42:43], v[44:45], v[60:61], v[46:47] op_sel:[1,1,0] op_sel_hi:[0,1,1] neg_lo:[1,0,0]
  v_cvt_pk_f16_f32 v48, v42, v43
  v_pk_fma_f32 v[32:33], v[28:29], v[62:63], v[38:39] op_sel:[1,1,0] op_sel_hi:[0,1,1] neg_lo:[1,0,0]
  ds_write_b32 v4, v48 offset:27456
  v_cvt_pk_f16_f32 v41, v32, -v33
  v_pk_mul_f32 v[46:47], v[42:43], v[60:61] op_sel:[0,0] op_sel_hi:[1,0]
  v_pk_fma_f32 v[44:45], v[42:43], v[60:61], v[46:47] op_sel:[1,1,0] op_sel_hi:[0,1,1] neg_lo:[1,0,0]
  ds_write_b32 v4, v41 offset:7392
  v_cvt_pk_f16_f32 v49, v44, v45
  v_pk_mul_f32 v[38:39], v[36:37], v[62:63] op_sel:[0,0] op_sel_hi:[1,0]
  ds_write_b32 v4, v49 offset:27984
  v_pk_mul_f32 v[46:47], v[44:45], v[60:61] op_sel:[0,0] op_sel_hi:[1,0]
  v_pk_fma_f32 v[34:35], v[36:37], v[62:63], v[38:39] op_sel:[1,1,0] op_sel_hi:[0,1,1] neg_lo:[1,0,0]
  v_pk_fma_f32 v[42:43], v[44:45], v[60:61], v[46:47] op_sel:[1,1,0] op_sel_hi:[0,1,1] neg_lo:[1,0,0]
  v_cvt_pk_f16_f32 v40, v34, -v35
  v_cvt_pk_f16_f32 v48, v42, v43
  ds_write_b32 v4, v48 offset:28512
  ds_write_b32 v4, v40 offset:5808
  v_pk_mul_f32 v[46:47], v[42:43], v[60:61] op_sel:[0,0] op_sel_hi:[1,0]
  v_pk_mul_f32 v[38:39], v[32:33], v[62:63] op_sel:[0,0] op_sel_hi:[1,0]
  v_pk_fma_f32 v[44:45], v[42:43], v[60:61], v[46:47] op_sel:[1,1,0] op_sel_hi:[0,1,1] neg_lo:[1,0,0]
  v_cvt_pk_f16_f32 v49, v44, v45
  v_pk_fma_f32 v[28:29], v[32:33], v[62:63], v[38:39] op_sel:[1,1,0] op_sel_hi:[0,1,1] neg_lo:[1,0,0]
  ds_write_b32 v4, v49 offset:29040
  v_cvt_pk_f16_f32 v41, v28, -v29
  v_pk_mul_f32 v[46:47], v[44:45], v[60:61] op_sel:[0,0] op_sel_hi:[1,0]
  ds_write_b32 v4, v41 offset:7920
  v_pk_fma_f32 v[42:43], v[44:45], v[60:61], v[46:47] op_sel:[1,1,0] op_sel_hi:[0,1,1] neg_lo:[1,0,0]
  v_cvt_pk_f16_f32 v48, v42, v43
  v_pk_mul_f32 v[38:39], v[34:35], v[62:63] op_sel:[0,0] op_sel_hi:[1,0]
  ds_write_b32 v4, v48 offset:29568
  v_pk_fma_f32 v[36:37], v[34:35], v[62:63], v[38:39] op_sel:[1,1,0] op_sel_hi:[0,1,1] neg_lo:[1,0,0]
  v_pk_mul_f32 v[46:47], v[42:43], v[60:61] op_sel:[0,0] op_sel_hi:[1,0]
  v_pk_fma_f32 v[44:45], v[42:43], v[60:61], v[46:47] op_sel:[1,1,0] op_sel_hi:[0,1,1] neg_lo:[1,0,0]
  v_cvt_pk_f16_f32 v40, v36, -v37
  v_cvt_pk_f16_f32 v49, v44, v45
  ds_write_b32 v4, v40 offset:8448
  ds_write_b32 v4, v49 offset:30096
  v_pk_mul_f32 v[46:47], v[44:45], v[60:61] op_sel:[0,0] op_sel_hi:[1,0]
  v_pk_mul_f32 v[38:39], v[36:37], v[62:63] op_sel:[0,0] op_sel_hi:[1,0]
  v_pk_fma_f32 v[42:43], v[44:45], v[60:61], v[46:47] op_sel:[1,1,0] op_sel_hi:[0,1,1] neg_lo:[1,0,0]
  v_pk_fma_f32 v[34:35], v[36:37], v[62:63], v[38:39] op_sel:[1,1,0] op_sel_hi:[0,1,1] neg_lo:[1,0,0]
  v_cvt_pk_f16_f32 v48, v42, v43
  ds_write_b32 v4, v48 offset:30624
  v_cvt_pk_f16_f32 v41, v34, -v35
  v_pk_mul_f32 v[46:47], v[42:43], v[60:61] op_sel:[0,0] op_sel_hi:[1,0]
  ds_write_b32 v4, v41 offset:10560
  v_pk_fma_f32 v[44:45], v[42:43], v[60:61], v[46:47] op_sel:[1,1,0] op_sel_hi:[0,1,1] neg_lo:[1,0,0]
  v_cvt_pk_f16_f32 v49, v44, v45
  v_pk_mul_f32 v[38:39], v[34:35], v[62:63] op_sel:[0,0] op_sel_hi:[1,0]
  ds_write_b32 v4, v49 offset:31152
  v_pk_fma_f32 v[36:37], v[34:35], v[62:63], v[38:39] op_sel:[1,1,0] op_sel_hi:[0,1,1] neg_lo:[1,0,0]
  v_pk_mul_f32 v[46:47], v[44:45], v[60:61] op_sel:[0,0] op_sel_hi:[1,0]
  v_pk_fma_f32 v[42:43], v[44:45], v[60:61], v[46:47] op_sel:[1,1,0] op_sel_hi:[0,1,1] neg_lo:[1,0,0]
  v_cvt_pk_f16_f32 v40, v36, -v37
  v_cvt_pk_f16_f32 v48, v42, v43
  ds_write_b32 v4, v40 offset:8976
  ds_write_b32 v4, v48 offset:31680
  v_pk_mul_f32 v[46:47], v[42:43], v[60:61] op_sel:[0,0] op_sel_hi:[1,0]
  v_pk_mul_f32 v[38:39], v[36:37], v[62:63] op_sel:[0,0] op_sel_hi:[1,0]
  v_pk_fma_f32 v[44:45], v[42:43], v[60:61], v[46:47] op_sel:[1,1,0] op_sel_hi:[0,1,1] neg_lo:[1,0,0]
  v_pk_fma_f32 v[34:35], v[36:37], v[62:63], v[38:39] op_sel:[1,1,0] op_sel_hi:[0,1,1] neg_lo:[1,0,0]
  v_cvt_pk_f16_f32 v49, v44, v45
  ds_write_b32 v4, v49 offset:32208
  v_cvt_pk_f16_f32 v41, v34, -v35
  v_pk_mul_f32 v[46:47], v[44:45], v[60:61] op_sel:[0,0] op_sel_hi:[1,0]
  ds_write_b32 v4, v41 offset:11088
  v_pk_fma_f32 v[42:43], v[44:45], v[60:61], v[46:47] op_sel:[1,1,0] op_sel_hi:[0,1,1] neg_lo:[1,0,0]
  v_cvt_pk_f16_f32 v48, v42, v43
  v_pk_mul_f32 v[38:39], v[34:35], v[62:63] op_sel:[0,0] op_sel_hi:[1,0]
  ds_write_b32 v4, v48 offset:32736
  v_pk_fma_f32 v[36:37], v[34:35], v[62:63], v[38:39] op_sel:[1,1,0] op_sel_hi:[0,1,1] neg_lo:[1,0,0]
  v_pk_mul_f32 v[46:47], v[42:43], v[60:61] op_sel:[0,0] op_sel_hi:[1,0]
  v_pk_fma_f32 v[44:45], v[42:43], v[60:61], v[46:47] op_sel:[1,1,0] op_sel_hi:[0,1,1] neg_lo:[1,0,0]
  v_cvt_pk_f16_f32 v40, v36, -v37
  v_cvt_pk_f16_f32 v49, v44, v45
  ds_write_b32 v4, v40 offset:9504
  ds_write_b32 v4, v49 offset:33264
  s_waitcnt lgkmcnt(0)
  s_waitcnt vmcnt(0)
  s_barrier
  s_cmp_lg_u32 s3, 0
  s_cbranch_scc1 L_p1
  s_mov_b32 s6, 30000
  s_lshr_b32 s7, s2, 2
  s_lshl_b32 s7, s7, 7
  s_and_b32 s14, s2, 3
  s_lshl_b32 s14, s14, 2
  s_add_u32 s7, s7, s14
  s_add_u32 s7, s7, 131072
  s_mov_b64 exec, 1
L_p1l:
  v_cmp_ne_u32 vcc, 0, v12
s_nop 4
  s_cbranch_vccnz L_p1s
  buffer_load_dword v12, off, s[64:67], 0 offset:252 sc1
  s_sub_u32 s6, s6, 1
  s_waitcnt vmcnt(0)
  s_cbranch_scc0 L_p1l
L_p1s:
  v_mov_b32 v12, 1
  buffer_store_dword v12, off, s[48:51], s7 sc1
  s_mov_b64 exec, -1
L_p1:
  s_add_u32 m0, s77, 0
s_nop 0
  buffer_load_dwordx4 v15, s[80:83], s89 offen lds
  s_add_u32 m0, s77, 1024
s_nop 0
  buffer_load_dwordx4 v15, s[80:83], s90 offen lds
  s_add_u32 m0, s77, 2048
s_nop 0
  buffer_load_dwordx4 v14, s[84:87], s91 offen lds
  s_add_u32 m0, s77, 3072
s_nop 0
  buffer_load_dwordx4 v14, s[84:87], s92 offen lds
  s_bitcmp1_b32 s3, 0
  s_cbranch_scc1 L_kskip
  s_lshr_b32 s8, s3, 1
  s_mul_i32 s9, s8, 33792
  s_add_u32 s9, s9, 81920
  v_and_b32 v4, 31, v1
  v_lshrrev_b32 v5, 5, v1
  v_mul_u32_u24 v6, 528, v4
  v_lshl_add_u32 v6, v5, 4, v6
  v_add_u32 v6, s9, v6
  ds_read_b128 v[24:27], v6 offset:0
  ds_read_b128 v[28:31], v6 offset:16896
  ds_read_b128 v[32:35], v6 offset:32
  ds_read_b128 v[36:39], v6 offset:16928
  ds_read_b128 v[40:43], v6 offset:64
  ds_read_b128 v[44:47], v6 offset:16960
  ds_read_b128 v[48:51], v6 offset:96
  ds_read_b128 v[52:55], v6 offset:16992
  s_waitcnt lgkmcnt(6)
  v_mfma_f32_32x32x16_f16 v[64:79], v[24:27], v[28:31], 0
  ds_read_b128 v[24:27], v6 offset:128
  ds_read_b128 v[28:31], v6 offset:17024
  s_waitcnt lgkmcnt(6)
  v_mfma_f32_32x32x16_f16 v[64:79], v[32:35], v[36:39], v[64:79]
  ds_read_b128 v[32:35], v6 offset:160
  ds_read_b128 v[36:39], v6 offset:17056
  s_waitcnt lgkmcnt(6)
  v_mfma_f32_32x32x16_f16 v[64:79], v[40:43], v[44:47], v[64:79]
  ds_read_b128 v[40:43], v6 offset:192
  ds_read_b128 v[44:47], v6 offset:17088
  s_waitcnt lgkmcnt(6)
  v_mfma_f32_32x32x16_f16 v[64:79], v[48:51], v[52:55], v[64:79]
  ds_read_b128 v[48:51], v6 offset:224
  ds_read_b128 v[52:55], v6 offset:17120
  s_waitcnt lgkmcnt(6)
  v_mfma_f32_32x32x16_f16 v[64:79], v[24:27], v[28:31], v[64:79]
  ds_read_b128 v[24:27], v6 offset:256
  ds_read_b128 v[28:31], v6 offset:17152
  s_waitcnt lgkmcnt(6)
  v_mfma_f32_32x32x16_f16 v[64:79], v[32:35], v[36:39], v[64:79]
  ds_read_b128 v[32:35], v6 offset:288
  ds_read_b128 v[36:39], v6 offset:17184
  s_waitcnt lgkmcnt(6)
  v_mfma_f32_32x32x16_f16 v[64:79], v[40:43], v[44:47], v[64:79]
  ds_read_b128 v[40:43], v6 offset:320
  ds_read_b128 v[44:47], v6 offset:17216
  s_waitcnt lgkmcnt(6)
  v_mfma_f32_32x32x16_f16 v[64:79], v[48:51], v[52:55], v[64:79]
  ds_read_b128 v[48:51], v6 offset:352
  ds_read_b128 v[52:55], v6 offset:17248
  s_waitcnt lgkmcnt(6)
  v_mfma_f32_32x32x16_f16 v[64:79], v[24:27], v[28:31], v[64:79]
  ds_read_b128 v[24:27], v6 offset:384
  ds_read_b128 v[28:31], v6 offset:17280
  s_waitcnt lgkmcnt(6)
  v_mfma_f32_32x32x16_f16 v[64:79], v[32:35], v[36:39], v[64:79]
  ds_read_b128 v[32:35], v6 offset:416
  ds_read_b128 v[36:39], v6 offset:17312
  s_waitcnt lgkmcnt(6)
  v_mfma_f32_32x32x16_f16 v[64:79], v[40:43], v[44:47], v[64:79]
  ds_read_b128 v[40:43], v6 offset:448
  ds_read_b128 v[44:47], v6 offset:17344
  s_waitcnt lgkmcnt(6)
  v_mfma_f32_32x32x16_f16 v[64:79], v[48:51], v[52:55], v[64:79]
  ds_read_b128 v[48:51], v6 offset:480
  ds_read_b128 v[52:55], v6 offset:17376
  s_waitcnt lgkmcnt(6)
  v_mfma_f32_32x32x16_f16 v[64:79], v[24:27], v[28:31], v[64:79]
  s_waitcnt lgkmcnt(4)
  v_mfma_f32_32x32x16_f16 v[64:79], v[32:35], v[36:39], v[64:79]
  s_waitcnt lgkmcnt(2)
  v_mfma_f32_32x32x16_f16 v[64:79], v[40:43], v[44:47], v[64:79]
  s_waitcnt lgkmcnt(0)
  v_mfma_f32_32x32x16_f16 v[64:79], v[48:51], v[52:55], v[64:79]
  s_mul_i32 s9, s8, 5376
  s_add_u32 s9, s9, 149504
  v_lshlrev_b32 v4, 4, v4
  v_add_u32 v4, s9, v4
  v_lshl_add_u32 v24, v5, 3, v4
  v_lshl_add_u32 v25, v5, 2, v4
  v_lshl_add_u32 v26, v5, 9, v4
s_nop 4
  v_cvt_pk_f16_f32 v28, v64, v65
  v_cvt_pk_f16_f32 v29, v66, v67
  v_cvt_pk_f16_f32 v30, v68, v69
  v_cvt_pk_f16_f32 v31, v70, v71
  v_cvt_pk_f16_f32 v32, v72, v73
  v_cvt_pk_f16_f32 v33, v74, v75
  ds_write_b64 v24, v[28:29]
  ds_write_b16 v25, v30 offset:512
  ds_write_b16_d16_hi v25, v30 offset:520
  ds_write_b16 v24, v31 offset:1024
  ds_write_b16_d16_hi v24, v31 offset:1536
  ds_write_b16 v26, v32 offset:2048
  ds_write_b16_d16_hi v26, v32 offset:3072
  ds_write_b16 v26, v33 offset:4096
  s_waitcnt lgkmcnt(0)
L_kskip:
  s_barrier
  v_lshlrev_b32 v4, 2, v0
  v_lshlrev_b32 v5, 4, v0
  ds_read_u16 v24, v16 offset:0
  ds_read_u16 v32, v17 offset:0
  ds_read_u16 v25, v18 offset:0
  ds_read_u16 v33, v19 offset:0
  ds_read_u16 v26, v20 offset:0
  ds_read_u16 v34, v21 offset:0
  ds_read_u16 v27, v22 offset:0
  ds_read_u16 v35, v23 offset:0
  ds_read_u16 v28, v16 offset:5376
  ds_read_u16 v36, v17 offset:5376
  ds_read_u16 v29, v18 offset:5376
  ds_read_u16 v37, v19 offset:5376
  ds_read_u16 v30, v20 offset:5376
  ds_read_u16 v38, v21 offset:5376
  ds_read_u16 v31, v22 offset:5376
  ds_read_u16 v39, v23 offset:5376
  s_waitcnt lgkmcnt(8)
  v_lshl_or_b32 v24, v32, 16, v24
  ds_write_b32 v4, v24 offset:0
  v_lshl_or_b32 v25, v33, 16, v25
  ds_write_b32 v4, v25 offset:1024
  v_lshl_or_b32 v26, v34, 16, v26
  ds_write_b32 v4, v26 offset:2048
  v_lshl_or_b32 v27, v35, 16, v27
  ds_write_b32 v4, v27 offset:3072
  s_waitcnt lgkmcnt(4)
  v_lshl_or_b32 v28, v36, 16, v28
  ds_write_b32 v4, v28 offset:33280
  v_lshl_or_b32 v29, v37, 16, v29
  ds_write_b32 v4, v29 offset:34304
  v_lshl_or_b32 v30, v38, 16, v30
  ds_write_b32 v4, v30 offset:35328
  v_lshl_or_b32 v31, v39, 16, v31
  ds_write_b32 v4, v31 offset:36352
  s_waitcnt lgkmcnt(0)
  s_barrier
  ds_read_b128 v[24:27], v5 offset:0
  ds_read_b128 v[28:31], v5 offset:16
  ds_read_b128 v[32:35], v5 offset:33280
  ds_read_b128 v[36:39], v5 offset:33296
  s_waitcnt lgkmcnt(2)
  v_alignbit_b32 v40, v25, v24, 16
  v_alignbit_b32 v41, v26, v25, 16
  v_alignbit_b32 v42, v27, v26, 16
  v_alignbit_b32 v43, v28, v27, 16
  v_alignbit_b32 v44, v29, v28, 16
  v_alignbit_b32 v45, v30, v29, 16
  v_alignbit_b32 v46, v31, v30, 16
  v_mov_b32 v48, v41
  v_mov_b32 v49, v42
  v_mov_b32 v50, v43
  v_mov_b32 v51, v44
  v_mov_b32 v52, v45
  v_mov_b32 v53, v46
  v_mov_b32 v56, v25
  v_mov_b32 v57, v26
  v_mov_b32 v58, v27
  v_mov_b32 v59, v28
  v_mov_b32 v60, v29
  v_mov_b32 v61, v30
  ds_write_b128 v5, v[40:43] offset:4160
  ds_write_b128 v5, v[56:59] offset:8320
  ds_write_b128 v5, v[48:51] offset:12480
  ds_write_b128 v5, v[26:29] offset:16640
  ds_write_b128 v5, v[42:45] offset:20800
  ds_write_b128 v5, v[58:61] offset:24960
  ds_write_b128 v5, v[50:53] offset:29120
  s_nop 1
  s_waitcnt lgkmcnt(7)
  v_alignbit_b32 v40, v33, v32, 16
  v_alignbit_b32 v41, v34, v33, 16
  v_alignbit_b32 v42, v35, v34, 16
  v_alignbit_b32 v43, v36, v35, 16
  v_alignbit_b32 v44, v37, v36, 16
  v_alignbit_b32 v45, v38, v37, 16
  v_alignbit_b32 v46, v39, v38, 16
  v_mov_b32 v48, v41
  v_mov_b32 v49, v42
  v_mov_b32 v50, v43
  v_mov_b32 v51, v44
  v_mov_b32 v52, v45
  v_mov_b32 v53, v46
  v_mov_b32 v56, v33
  v_mov_b32 v57, v34
  v_mov_b32 v58, v35
  v_mov_b32 v59, v36
  v_mov_b32 v60, v37
  v_mov_b32 v61, v38
  ds_write_b128 v5, v[40:43] offset:37440
  ds_write_b128 v5, v[56:59] offset:41600
  ds_write_b128 v5, v[48:51] offset:45760
  ds_write_b128 v5, v[34:37] offset:49920
  ds_write_b128 v5, v[42:45] offset:54080
  ds_write_b128 v5, v[58:61] offset:58240
  ds_write_b128 v5, v[50:53] offset:62400
  v_add_u32 v14, s77, v3
  s_waitcnt vmcnt(0)
  v_lshlrev_b32 v116, 7, v1
  s_mov_b32 s40, 131072
  buffer_load_dwordx4 v[112:115], v116, s[48:51], s40 offen sc1
  ds_read_b64_tr_b16 v[128:129], v14 offset:0
  ds_read_b64_tr_b16 v[130:131], v14 offset:512
  ds_read_b64_tr_b16 v[132:133], v14 offset:1024
  ds_read_b64_tr_b16 v[134:135], v14 offset:1536
  ds_read_b64_tr_b16 v[136:137], v14 offset:2048
  ds_read_b64_tr_b16 v[138:139], v14 offset:2560
  ds_read_b64_tr_b16 v[140:141], v14 offset:3072
  ds_read_b64_tr_b16 v[142:143], v14 offset:3584
  s_and_b32 s32, s4, 3
  s_add_u32 s33, s32, s3
  s_and_b32 s33, s33, 3
  s_lshl_b32 s32, s32, 13
  s_lshl_b32 s8, s72, 2
  s_add_u32 s8, s8, s3
  s_lshl_b32 s8, s8, 15
  s_add_u32 s88, s8, 16777216
  s_add_u32 s89, s8, 17301504
  s_min_u32 s8, s74, 13
  s_lshl_b32 s8, s8, 2
  s_add_u32 s8, s8, s3
  s_lshl_b32 s8, s8, 15
  s_add_u32 s90, s8, 17825792
  s_mul_i32 s8, s76, 229376
  s_mul_i32 s9, s33, 28672
  s_add_u32 s8, s8, s9
  s_add_u32 s91, s8, 19922944
  s_add_u32 s92, s91, 114688
  s_bitcmp1_b32 s3, 0
  s_cselect_b32 s8, s92, s91
  s_cselect_b32 s92, s91, s92
  s_mov_b32 s91, s8
  v_lshrrev_b32 v4, 2, v0
  v_mul_u32_u24 v4, 80, v4
  v_and_b32 v5, 3, v0
  v_lshl_add_u32 v4, v5, 4, v4
  v_add_u32 v23, 69040, v4
  s_lshr_b32 s8, s3, 1
  s_and_b32 s9, s3, 1
  s_mul_i32 s10, s8, 33280
  s_lshl_b32 s11, s9, 5
  s_add_u32 s10, s10, s11
  s_add_u32 s10, s10, 29168
  s_mul_i32 s8, s8, 7680
  s_add_u32 s8, s8, s11
  s_add_u32 s8, s8, 66560
  v_and_b32 v16, 31, v1
  v_lshrrev_b32 v17, 5, v1
  v_and_b32 v18, 7, v1
  v_mul_u32_u24 v18, 4160, v18
  v_sub_u32 v4, s10, v18
  v_lshrrev_b32 v18, 3, v16
  v_sub_u32 v18, v17, v18
  v_lshl_add_u32 v4, v18, 4, v4
  v_mul_u32_u24 v21, 80, v16
  v_lshl_add_u32 v21, v17, 4, v21
  v_add_u32 v21, s8, v21
  v_lshlrev_b32 v19, 5, v0
  v_lshlrev_b32 v20, 6, v0
  s_lshr_b32 s12, s70, 2
  s_lshl_b32 s12, s12, 14
  s_and_b32 s13, s70, 3
  s_lshl_b32 s13, s13, 4
  s_add_u32 s12, s12, s13
  s_add_u32 s12, s12, 22020096
  s_mov_b32 s13, 36864
  s_lshl_b32 s8, s78, 16
  s_and_b32 s9, s78, s69
  s_cmp_lg_u32 s3, 0
  s_cbranch_scc1 P1_done
  s_mov_b32 s6, 30000
P1_loop:
  s_waitcnt vmcnt(0)
  v_and_b32 v112, v112, v113
  v_and_b32 v114, v114, v115
  v_and_b32 v112, v112, v114
  v_cmp_ne_u32 vcc, 1, v112
s_nop 4
  s_cbranch_vccz P1_done
  buffer_load_dwordx4 v[112:115], v116, s[48:51], s40 offen sc1
  s_sub_u32 s6, s6, 1
  s_cbranch_scc0 P1_loop
P1_done:
  s_waitcnt lgkmcnt(0)
  s_barrier
  buffer_load_dwordx4 v[24:27], v19, s[48:51], s13 offen sc1
  buffer_load_dwordx4 v[28:31], v19, s[48:51], s13 offen offset:16 sc1
  buffer_load_dwordx4 v[8:11], v20, s[48:51], s12 offen sc1
  buffer_load_dwordx4 v[12:15], v20, s[48:51], s12 offen offset:16 sc1
  s_add_u32 s46, s88, 0
  buffer_load_dwordx4 a[0:3], v2, s[48:51], s46 offen offset:0 sc1
  buffer_load_dwordx4 a[4:7], v2, s[48:51], s46 offen offset:1024 sc1
  buffer_load_dwordx4 a[8:11], v2, s[48:51], s46 offen offset:2048 sc1
  buffer_load_dwordx4 a[12:15], v2, s[48:51], s46 offen offset:3072 sc1
  s_add_u32 s46, s88, 4096
  buffer_load_dwordx4 a[16:19], v2, s[48:51], s46 offen offset:0 sc1
  buffer_load_dwordx4 a[20:23], v2, s[48:51], s46 offen offset:1024 sc1
  buffer_load_dwordx4 a[24:27], v2, s[48:51], s46 offen offset:2048 sc1
  buffer_load_dwordx4 a[28:31], v2, s[48:51], s46 offen offset:3072 sc1
  v_mov_b32 v5, v21
  s_waitcnt vmcnt(8)
  v_and_b32 v48, s69, v24
  v_lshlrev_b32 v24, 16, v24
  v_rcp_f32 v48, v48
  v_and_b32 v49, s69, v25
  v_lshlrev_b32 v25, 16, v25
  v_rcp_f32 v49, v49
  v_and_b32 v50, s69, v26
  v_lshlrev_b32 v26, 16, v26
  v_rcp_f32 v50, v50
  v_and_b32 v51, s69, v27
  v_lshlrev_b32 v27, 16, v27
  v_rcp_f32 v51, v51
  v_and_b32 v52, s69, v28
  v_lshlrev_b32 v28, 16, v28
  s_add_u32 s46, s88, 8192
  buffer_load_dwordx4 a[32:35], v2, s[48:51], s46 offen offset:0 sc1
  v_rcp_f32 v52, v52
  v_and_b32 v53, s69, v29
  v_lshlrev_b32 v29, 16, v29
  v_rcp_f32 v53, v53
  v_and_b32 v54, s69, v30
  v_lshlrev_b32 v30, 16, v30
  v_rcp_f32 v54, v54
  v_and_b32 v55, s69, v31
  v_lshlrev_b32 v31, 16, v31
  v_rcp_f32 v55, v55
  v_lshlrev_b32 v32, 16, v8
  v_and_b32 v33, s69, v8
  v_pk_add_f32 v[32:33], v[32:33], v[24:25] neg_lo:[0,1] neg_hi:[0,1]
  v_lshlrev_b32 v34, 16, v9
  buffer_load_dwordx4 a[36:39], v2, s[48:51], s46 offen offset:1024 sc1
  v_and_b32 v35, s69, v9
  v_pk_add_f32 v[34:35], v[34:35], v[26:27] neg_lo:[0,1] neg_hi:[0,1]
  v_lshlrev_b32 v36, 16, v10
  v_and_b32 v37, s69, v10
  v_pk_add_f32 v[36:37], v[36:37], v[28:29] neg_lo:[0,1] neg_hi:[0,1]
  v_lshlrev_b32 v38, 16, v11
  v_and_b32 v39, s69, v11
  v_pk_add_f32 v[38:39], v[38:39], v[30:31] neg_lo:[0,1] neg_hi:[0,1]
  v_cvt_pk_bf16_f32 v64, v32, v33
  v_cvt_pk_bf16_f32 v65, v34, v35
  v_cvt_pk_bf16_f32 v66, v36, v37
  v_cvt_pk_bf16_f32 v67, v38, v39
  v_lshlrev_b32 v32, 16, v64
  v_and_b32 v33, s69, v64
  buffer_load_dwordx4 a[40:43], v2, s[48:51], s46 offen offset:2048 sc1
  v_lshlrev_b32 v34, 16, v65
  v_and_b32 v35, s69, v65
  v_lshlrev_b32 v36, 16, v66
  v_and_b32 v37, s69, v66
  v_lshlrev_b32 v38, 16, v67
  v_and_b32 v39, s69, v67
  v_pk_mul_f32 v[32:33], v[32:33], v[48:49]
  v_pk_mul_f32 v[34:35], v[34:35], v[50:51]
  v_pk_mul_f32 v[36:37], v[36:37], v[52:53]
  v_pk_mul_f32 v[38:39], v[38:39], v[54:55]
  v_cvt_pk_bf16_f32 v64, v32, v33
  v_cvt_pk_bf16_f32 v65, v34, v35
  v_cvt_pk_bf16_f32 v66, v36, v37
  v_cvt_pk_bf16_f32 v67, v38, v39
  buffer_load_dwordx4 a[44:47], v2, s[48:51], s46 offen offset:3072 sc1
  v_lshlrev_b32 v32, 16, v64
  v_and_b32 v33, s69, v64
  v_lshlrev_b32 v34, 16, v65
  v_and_b32 v35, s69, v65
  v_lshlrev_b32 v36, 16, v66
  v_and_b32 v37, s69, v66
  v_lshlrev_b32 v38, 16, v67
  v_and_b32 v39, s69, v67
  v_cvt_pk_f16_f32 v56, v32, v33
  v_cvt_pk_f16_f32 v57, v34, v35
  v_cvt_pk_f16_f32 v58, v36, v37
  v_cvt_pk_f16_f32 v59, v38, v39
  ds_write_b128 v23, v[56:59] offset:0
  v_lshlrev_b32 v40, 16, v12
  s_add_u32 s46, s88, 12288
  buffer_load_dwordx4 a[48:51], v2, s[48:51], s46 offen offset:0 sc1
  v_and_b32 v41, s69, v12
  v_pk_add_f32 v[40:41], v[40:41], v[24:25] neg_lo:[0,1] neg_hi:[0,1]
  v_lshlrev_b32 v42, 16, v13
  v_and_b32 v43, s69, v13
  v_pk_add_f32 v[42:43], v[42:43], v[26:27] neg_lo:[0,1] neg_hi:[0,1]
  v_lshlrev_b32 v44, 16, v14
  v_and_b32 v45, s69, v14
  v_pk_add_f32 v[44:45], v[44:45], v[28:29] neg_lo:[0,1] neg_hi:[0,1]
  v_lshlrev_b32 v46, 16, v15
  v_and_b32 v47, s69, v15
  v_pk_add_f32 v[46:47], v[46:47], v[30:31] neg_lo:[0,1] neg_hi:[0,1]
  v_cvt_pk_bf16_f32 v64, v40, v41
  v_cvt_pk_bf16_f32 v65, v42, v43
  v_cvt_pk_bf16_f32 v66, v44, v45
  buffer_load_dwordx4 a[52:55], v2, s[48:51], s46 offen offset:1024 sc1
  v_cvt_pk_bf16_f32 v67, v46, v47
  v_lshlrev_b32 v40, 16, v64
  v_and_b32 v41, s69, v64
  v_lshlrev_b32 v42, 16, v65
  v_and_b32 v43, s69, v65
  v_lshlrev_b32 v44, 16, v66
  v_and_b32 v45, s69, v66
  v_lshlrev_b32 v46, 16, v67
  v_and_b32 v47, s69, v67
  v_pk_mul_f32 v[40:41], v[40:41], v[48:49]
  v_pk_mul_f32 v[42:43], v[42:43], v[50:51]
  v_pk_mul_f32 v[44:45], v[44:45], v[52:53]
  v_pk_mul_f32 v[46:47], v[46:47], v[54:55]
  v_cvt_pk_bf16_f32 v64, v40, v41
  buffer_load_dwordx4 a[56:59], v2, s[48:51], s46 offen offset:2048 sc1
  v_cvt_pk_bf16_f32 v65, v42, v43
  v_cvt_pk_bf16_f32 v66, v44, v45
  v_cvt_pk_bf16_f32 v67, v46, v47
  v_lshlrev_b32 v40, 16, v64
  v_and_b32 v41, s69, v64
  v_lshlrev_b32 v42, 16, v65
  v_and_b32 v43, s69, v65
  v_lshlrev_b32 v44, 16, v66
  v_and_b32 v45, s69, v66
  v_lshlrev_b32 v46, 16, v67
  v_and_b32 v47, s69, v67
  v_cvt_pk_f16_f32 v60, v40, v41
  v_cvt_pk_f16_f32 v61, v42, v43
  v_cvt_pk_f16_f32 v62, v44, v45
  buffer_load_dwordx4 a[60:63], v2, s[48:51], s46 offen offset:3072 sc1
  v_cvt_pk_f16_f32 v63, v46, v47
  ds_write_b128 v23, v[60:63] offset:7680
  s_waitcnt lgkmcnt(0)
  s_barrier
  ds_read_b128 v[48:51], v4 offset:4032
  ds_read_b128 v[52:55], v5 offset:5040
  ds_read_b128 v[56:59], v5 offset:2480
  ds_read_b128 v[60:63], v4 offset:1984
  ds_read_b128 v[96:99], v4 offset:3968
  ds_read_b128 v[100:103], v5 offset:4960
  ds_read_b128 v[104:107], v5 offset:2400
  ds_read_b128 v[108:111], v4 offset:1920
  s_waitcnt lgkmcnt(4)
  v_mfma_f32_32x32x16_f16 v[80:95], v[48:51], v[52:55], 0
  ds_read_b128 v[112:115], v4 offset:3904
  ds_read_b128 v[116:119], v5 offset:4880
  ds_read_b128 v[120:123], v5 offset:2320
  ds_read_b128 v[124:127], v4 offset:1856
  v_mfma_f32_32x32x16_f16 v[64:79], v[48:51], v[56:59], 0
  s_add_u32 s46, s88, 16384
  buffer_load_dwordx4 a[64:67], v2, s[48:51], s46 offen offset:0 sc1
  v_mul_f32 v32, s8, v32
  v_mul_f32 v33, s8, v33
  v_mfma_f32_32x32x16_f16 v[80:95], v[60:63], v[56:59], v[80:95]
  buffer_store_dwordx4 v[128:131], v2, s[48:51], s97 offen sc1
  v_cvt_pk_bf16_f32 v18, v32, v33
  v_and_b32 v33, s69, v18
  s_waitcnt lgkmcnt(4)
  v_mfma_f32_32x32x16_f16 v[80:95], v[96:99], v[100:103], v[80:95]
  ds_read_b128 v[48:51], v4 offset:3840
  ds_read_b128 v[52:55], v5 offset:4800
  ds_read_b128 v[56:59], v5 offset:2240
  ds_read_b128 v[60:63], v4 offset:1792
  v_mfma_f32_32x32x16_f16 v[64:79], v[96:99], v[104:107], v[64:79]
  buffer_load_dwordx4 a[68:71], v2, s[48:51], s46 offen offset:1024 sc1
  v_lshlrev_b32 v32, 16, v18
  v_mul_f32 v34, s8, v34
  v_mfma_f32_32x32x16_f16 v[80:95], v[108:111], v[104:107], v[80:95]
  v_mul_f32 v35, s8, v35
  v_cvt_pk_bf16_f32 v18, v34, v35
  s_waitcnt lgkmcnt(4)
  v_mfma_f32_32x32x16_f16 v[80:95], v[112:115], v[116:119], v[80:95]
  ds_read_b128 v[96:99], v4 offset:3776
  ds_read_b128 v[100:103], v5 offset:4720
  ds_read_b128 v[104:107], v5 offset:2160
  ds_read_b128 v[108:111], v4 offset:1728
  v_mfma_f32_32x32x16_f16 v[64:79], v[112:115], v[120:123], v[64:79]
  buffer_load_dwordx4 a[72:75], v2, s[48:51], s46 offen offset:2048 sc1
  v_and_b32 v35, s69, v18
  v_lshlrev_b32 v34, 16, v18
  v_mfma_f32_32x32x16_f16 v[80:95], v[124:127], v[120:123], v[80:95]
  v_mul_f32 v36, s8, v36
  v_mul_f32 v37, s8, v37
  s_waitcnt lgkmcnt(4)
  v_mfma_f32_32x32x16_f16 v[80:95], v[48:51], v[52:55], v[80:95]
  ds_read_b128 v[112:115], v4 offset:3712
  ds_read_b128 v[116:119], v5 offset:4640
  ds_read_b128 v[120:123], v5 offset:2080
  ds_read_b128 v[124:127], v4 offset:1664
  v_mfma_f32_32x32x16_f16 v[64:79], v[48:51], v[56:59], v[64:79]
  buffer_load_dwordx4 a[76:79], v2, s[48:51], s46 offen offset:3072 sc1
  v_cvt_pk_bf16_f32 v18, v36, v37
  v_and_b32 v37, s69, v18
  v_mfma_f32_32x32x16_f16 v[80:95], v[60:63], v[56:59], v[80:95]
  v_lshlrev_b32 v36, 16, v18
  v_mul_f32 v38, s8, v38
  s_waitcnt lgkmcnt(4)
  v_mfma_f32_32x32x16_f16 v[80:95], v[96:99], v[100:103], v[80:95]
  ds_read_b128 v[48:51], v4 offset:3648
  ds_read_b128 v[52:55], v5 offset:4560
  ds_read_b128 v[56:59], v5 offset:2000
  ds_read_b128 v[60:63], v4 offset:1600
  v_mfma_f32_32x32x16_f16 v[64:79], v[96:99], v[104:107], v[64:79]
  s_add_u32 s46, s88, 20480
  buffer_load_dwordx4 a[80:83], v2, s[48:51], s46 offen offset:0 sc1
  v_mul_f32 v39, s8, v39
  v_cvt_pk_bf16_f32 v18, v38, v39
  v_mfma_f32_32x32x16_f16 v[80:95], v[108:111], v[104:107], v[80:95]
  buffer_store_dwordx4 v[132:135], v2, s[48:51], s98 offen sc1
  v_and_b32 v39, s69, v18
  v_lshlrev_b32 v38, 16, v18
  s_waitcnt lgkmcnt(4)
  v_mfma_f32_32x32x16_f16 v[80:95], v[112:115], v[116:119], v[80:95]
  ds_read_b128 v[96:99], v4 offset:3584
  ds_read_b128 v[100:103], v5 offset:4480
  ds_read_b128 v[104:107], v5 offset:1920
  ds_read_b128 v[108:111], v4 offset:1536
  v_mfma_f32_32x32x16_f16 v[64:79], v[112:115], v[120:123], v[64:79]
  buffer_load_dwordx4 a[84:87], v2, s[48:51], s46 offen offset:1024 sc1
  v_mul_f32 v40, s9, v40
  v_mul_f32 v41, s9, v41
  v_mfma_f32_32x32x16_f16 v[80:95], v[124:127], v[120:123], v[80:95]
  v_cvt_pk_bf16_f32 v18, v40, v41
  v_and_b32 v41, s69, v18
  s_waitcnt lgkmcnt(4)
  v_mfma_f32_32x32x16_f16 v[80:95], v[48:51], v[52:55], v[80:95]
  ds_read_b128 v[112:115], v4 offset:3520
  ds_read_b128 v[116:119], v5 offset:4400
  ds_read_b128 v[120:123], v5 offset:1840
  ds_read_b128 v[124:127], v4 offset:1472
  v_mfma_f32_32x32x16_f16 v[64:79], v[48:51], v[56:59], v[64:79]
  buffer_load_dwordx4 a[88:91], v2, s[48:51], s46 offen offset:2048 sc1
  v_lshlrev_b32 v40, 16, v18
  v_mul_f32 v42, s9, v42
  v_mfma_f32_32x32x16_f16 v[80:95], v[60:63], v[56:59], v[80:95]
  v_mul_f32 v43, s9, v43
  v_cvt_pk_bf16_f32 v18, v42, v43
  s_waitcnt lgkmcnt(4)
  v_mfma_f32_32x32x16_f16 v[80:95], v[96:99], v[100:103], v[80:95]
  ds_read_b128 v[48:51], v4 offset:3456
  ds_read_b128 v[52:55], v5 offset:4320
  ds_read_b128 v[56:59], v5 offset:1760
  ds_read_b128 v[60:63], v4 offset:1408
  v_mfma_f32_32x32x16_f16 v[64:79], v[96:99], v[104:107], v[64:79]
  buffer_load_dwordx4 a[92:95], v2, s[48:51], s46 offen offset:3072 sc1
  v_and_b32 v43, s69, v18
  v_lshlrev_b32 v42, 16, v18
  v_mfma_f32_32x32x16_f16 v[80:95], v[108:111], v[104:107], v[80:95]
  v_mul_f32 v44, s9, v44
  v_mul_f32 v45, s9, v45
  s_waitcnt lgkmcnt(4)
  v_mfma_f32_32x32x16_f16 v[80:95], v[112:115], v[116:119], v[80:95]
  ds_read_b128 v[96:99], v4 offset:3392
  ds_read_b128 v[100:103], v5 offset:4240
  ds_read_b128 v[104:107], v5 offset:1680
  ds_read_b128 v[108:111], v4 offset:1344
  v_mfma_f32_32x32x16_f16 v[64:79], v[112:115], v[120:123], v[64:79]
  s_add_u32 s46, s88, 24576
  buffer_load_dwordx4 a[96:99], v2, s[48:51], s46 offen offset:0 sc1
  v_cvt_pk_bf16_f32 v18, v44, v45
  v_and_b32 v45, s69, v18
  v_mfma_f32_32x32x16_f16 v[80:95], v[124:127], v[120:123], v[80:95]
  buffer_store_dwordx4 v[136:139], v2, s[48:51], s99 offen sc1
  v_lshlrev_b32 v44, 16, v18
  v_mul_f32 v46, s9, v46
  s_waitcnt lgkmcnt(4)
  v_mfma_f32_32x32x16_f16 v[80:95], v[48:51], v[52:55], v[80:95]
  ds_read_b128 v[112:115], v4 offset:3328
  ds_read_b128 v[116:119], v5 offset:4160
  ds_read_b128 v[120:123], v5 offset:1600
  ds_read_b128 v[124:127], v4 offset:1280
  v_mfma_f32_32x32x16_f16 v[64:79], v[48:51], v[56:59], v[64:79]
  buffer_load_dwordx4 a[100:103], v2, s[48:51], s46 offen offset:1024 sc1
  v_mul_f32 v47, s9, v47
  v_cvt_pk_bf16_f32 v18, v46, v47
  v_mfma_f32_32x32x16_f16 v[80:95], v[60:63], v[56:59], v[80:95]
  v_and_b32 v47, s69, v18
  v_lshlrev_b32 v46, 16, v18
  s_waitcnt lgkmcnt(4)
  v_mfma_f32_32x32x16_f16 v[80:95], v[96:99], v[100:103], v[80:95]
  ds_read_b128 v[48:51], v4 offset:3264
  ds_read_b128 v[52:55], v5 offset:4080
  ds_read_b128 v[56:59], v5 offset:1520
  ds_read_b128 v[60:63], v4 offset:1216
  v_mfma_f32_32x32x16_f16 v[64:79], v[96:99], v[104:107], v[64:79]
  buffer_load_dwordx4 a[104:107], v2, s[48:51], s46 offen offset:2048 sc1
  s_mul_i32 s10, s3, 9216
  s_add_u32 s10, s10, 81920
  v_mfma_f32_32x32x16_f16 v[80:95], v[108:111], v[104:107], v[80:95]
  v_mul_u32_u24 v19, 144, v16
  v_lshl_add_u32 v19, v17, 4, v19
  s_waitcnt lgkmcnt(4)
  v_mfma_f32_32x32x16_f16 v[80:95], v[112:115], v[116:119], v[80:95]
  ds_read_b128 v[96:99], v4 offset:3200
  ds_read_b128 v[100:103], v5 offset:4000
  ds_read_b128 v[104:107], v5 offset:1440
  ds_read_b128 v[108:111], v4 offset:1152
  v_mfma_f32_32x32x16_f16 v[64:79], v[112:115], v[120:123], v[64:79]
  buffer_load_dwordx4 a[108:111], v2, s[48:51], s46 offen offset:3072 sc1
  v_add_u32 v19, s10, v19
  v_lshrrev_b32 v20, 2, v0
  v_mfma_f32_32x32x16_f16 v[80:95], v[124:127], v[120:123], v[80:95]
  v_and_b32 v21, 3, v0
  v_lshlrev_b32 v22, 15, v20
  s_waitcnt lgkmcnt(4)
  v_mfma_f32_32x32x16_f16 v[80:95], v[48:51], v[52:55], v[80:95]
  ds_read_b128 v[112:115], v4 offset:3136
  ds_read_b128 v[116:119], v5 offset:3920
  ds_read_b128 v[120:123], v5 offset:1360
  ds_read_b128 v[124:127], v4 offset:1088
  v_mfma_f32_32x32x16_f16 v[64:79], v[48:51], v[56:59], v[64:79]
  s_add_u32 s46, s88, 28672
  buffer_load_dwordx4 a[112:115], v2, s[48:51], s46 offen offset:0 sc1
  v_lshl_add_u32 v22, v21, 4, v22
  v_mul_u32_u24 v20, 144, v20
  v_mfma_f32_32x32x16_f16 v[80:95], v[60:63], v[56:59], v[80:95]
  buffer_store_dwordx4 v[140:143], v2, s[48:51], s100 offen sc1
  v_lshl_add_u32 v20, v21, 5, v20
  v_add_u32 v20, 81920, v20
  s_waitcnt lgkmcnt(4)
  v_mfma_f32_32x32x16_f16 v[80:95], v[96:99], v[100:103], v[80:95]
  ds_read_b128 v[48:51], v4 offset:3072
  ds_read_b128 v[52:55], v5 offset:3840
  ds_read_b128 v[56:59], v5 offset:1280
  ds_read_b128 v[60:63], v4 offset:1024
  v_mfma_f32_32x32x16_f16 v[64:79], v[96:99], v[104:107], v[64:79]
  buffer_load_dwordx4 a[116:119], v2, s[48:51], s46 offen offset:1024 sc1
  v_mov_b32 v21, 160256
  ds_read_b64 v[24:25], v21
  v_mfma_f32_32x32x16_f16 v[80:95], v[108:111], v[104:107], v[80:95]
  s_lshl_b32 s10, s70, 6
  s_add_u32 s10, s10, 1048576
  s_waitcnt lgkmcnt(5)
  v_mfma_f32_32x32x16_f16 v[80:95], v[112:115], v[116:119], v[80:95]
  ds_read_b128 v[96:99], v4 offset:3008
  ds_read_b128 v[100:103], v5 offset:3760
  ds_read_b128 v[104:107], v5 offset:1200
  ds_read_b128 v[108:111], v4 offset:960
  v_mfma_f32_32x32x16_f16 v[64:79], v[112:115], v[120:123], v[64:79]
  buffer_load_dwordx4 a[120:123], v2, s[48:51], s46 offen offset:2048 sc1
  v_mov_b32 v6, 1
  s_lshl_b32 s11, s2, 7
  v_mfma_f32_32x32x16_f16 v[80:95], v[124:127], v[120:123], v[80:95]
  s_add_u32 s11, s11, 4
  s_waitcnt lgkmcnt(5)
  v_mfma_f32_32x32x16_f16 v[80:95], v[48:51], v[52:55], v[80:95]
  ds_read_b128 v[112:115], v4 offset:2944
  ds_read_b128 v[116:119], v5 offset:3680
  ds_read_b128 v[120:123], v5 offset:1120
  ds_read_b128 v[124:127], v4 offset:896
  v_mfma_f32_32x32x16_f16 v[64:79], v[48:51], v[56:59], v[64:79]
  buffer_load_dwordx4 a[124:127], v2, s[48:51], s46 offen offset:3072 sc1
  v_mfma_f32_32x32x16_f16 v[80:95], v[60:63], v[56:59], v[80:95]
  s_waitcnt lgkmcnt(4)
  v_mfma_f32_32x32x16_f16 v[80:95], v[96:99], v[100:103], v[80:95]
  ds_read_b128 v[48:51], v4 offset:2880
  ds_read_b128 v[52:55], v5 offset:3600
  ds_read_b128 v[56:59], v5 offset:1040
  ds_read_b128 v[60:63], v4 offset:832
  v_mfma_f32_32x32x16_f16 v[64:79], v[96:99], v[104:107], v[64:79]
  s_add_u32 s46, s89, 0
  buffer_load_dwordx4 a[128:131], v2, s[48:51], s46 offen offset:0 sc1
  v_mfma_f32_32x32x16_f16 v[80:95], v[108:111], v[104:107], v[80:95]
  buffer_load_dwordx4 a[132:135], v2, s[48:51], s46 offen offset:1024 sc1
  s_waitcnt lgkmcnt(4)
  v_mfma_f32_32x32x16_f16 v[80:95], v[112:115], v[116:119], v[80:95]
  ds_read_b128 v[96:99], v4 offset:2816
  ds_read_b128 v[100:103], v5 offset:3520
  ds_read_b128 v[104:107], v5 offset:960
  ds_read_b128 v[108:111], v4 offset:768
  v_mfma_f32_32x32x16_f16 v[64:79], v[112:115], v[120:123], v[64:79]
  buffer_load_dwordx4 a[136:139], v2, s[48:51], s46 offen offset:2048 sc1
  v_mfma_f32_32x32x16_f16 v[80:95], v[124:127], v[120:123], v[80:95]
  s_waitcnt lgkmcnt(4)
  v_mfma_f32_32x32x16_f16 v[80:95], v[48:51], v[52:55], v[80:95]
  ds_read_b128 v[112:115], v4 offset:2752
  ds_read_b128 v[116:119], v5 offset:3440
  ds_read_b128 v[120:123], v5 offset:880
  ds_read_b128 v[124:127], v4 offset:704
  v_mfma_f32_32x32x16_f16 v[64:79], v[48:51], v[56:59], v[64:79]
  buffer_load_dwordx4 a[140:143], v2, s[48:51], s46 offen offset:3072 sc1
  v_mfma_f32_32x32x16_f16 v[80:95], v[60:63], v[56:59], v[80:95]
  s_waitcnt lgkmcnt(4)
  v_mfma_f32_32x32x16_f16 v[80:95], v[96:99], v[100:103], v[80:95]
  ds_read_b128 v[48:51], v4 offset:2688
  ds_read_b128 v[52:55], v5 offset:3360
  ds_read_b128 v[56:59], v5 offset:800
  ds_read_b128 v[60:63], v4 offset:640
  v_mfma_f32_32x32x16_f16 v[64:79], v[96:99], v[104:107], v[64:79]
  s_add_u32 s46, s89, 4096
  buffer_load_dwordx4 a[144:147], v2, s[48:51], s46 offen offset:0 sc1
  v_mfma_f32_32x32x16_f16 v[80:95], v[108:111], v[104:107], v[80:95]
  s_waitcnt lgkmcnt(4)
  v_mfma_f32_32x32x16_f16 v[80:95], v[112:115], v[116:119], v[80:95]
  ds_read_b128 v[96:99], v4 offset:2624
  ds_read_b128 v[100:103], v5 offset:3280
  ds_read_b128 v[104:107], v5 offset:720
  ds_read_b128 v[108:111], v4 offset:576
  v_mfma_f32_32x32x16_f16 v[64:79], v[112:115], v[120:123], v[64:79]
  buffer_load_dwordx4 a[148:151], v2, s[48:51], s46 offen offset:1024 sc1
  v_mfma_f32_32x32x16_f16 v[80:95], v[124:127], v[120:123], v[80:95]
  buffer_load_dwordx4 a[152:155], v2, s[48:51], s46 offen offset:2048 sc1
  s_waitcnt lgkmcnt(4)
  v_mfma_f32_32x32x16_f16 v[80:95], v[48:51], v[52:55], v[80:95]
  ds_read_b128 v[112:115], v4 offset:2560
  ds_read_b128 v[116:119], v5 offset:3200
  ds_read_b128 v[120:123], v5 offset:640
  ds_read_b128 v[124:127], v4 offset:512
  v_mfma_f32_32x32x16_f16 v[64:79], v[48:51], v[56:59], v[64:79]
  buffer_load_dwordx4 a[156:159], v2, s[48:51], s46 offen offset:3072 sc1
  v_mfma_f32_32x32x16_f16 v[80:95], v[60:63], v[56:59], v[80:95]
  s_waitcnt lgkmcnt(4)
  v_mfma_f32_32x32x16_f16 v[80:95], v[96:99], v[100:103], v[80:95]
  ds_read_b128 v[48:51], v4 offset:2496
  ds_read_b128 v[52:55], v5 offset:3120
  ds_read_b128 v[56:59], v5 offset:560
  ds_read_b128 v[60:63], v4 offset:448
  v_mfma_f32_32x32x16_f16 v[64:79], v[96:99], v[104:107], v[64:79]
  s_add_u32 s46, s89, 8192
  buffer_load_dwordx4 a[160:163], v2, s[48:51], s46 offen offset:0 sc1
  v_mfma_f32_32x32x16_f16 v[80:95], v[108:111], v[104:107], v[80:95]
  s_waitcnt lgkmcnt(4)
  v_mfma_f32_32x32x16_f16 v[80:95], v[112:115], v[116:119], v[80:95]
  ds_read_b128 v[96:99], v4 offset:2432
  ds_read_b128 v[100:103], v5 offset:3040
  ds_read_b128 v[104:107], v5 offset:480
  ds_read_b128 v[108:111], v4 offset:384
  v_mfma_f32_32x32x16_f16 v[64:79], v[112:115], v[120:123], v[64:79]
  buffer_load_dwordx4 a[164:167], v2, s[48:51], s46 offen offset:1024 sc1
  v_mfma_f32_32x32x16_f16 v[80:95], v[124:127], v[120:123], v[80:95]
  s_waitcnt lgkmcnt(4)
  v_mfma_f32_32x32x16_f16 v[80:95], v[48:51], v[52:55], v[80:95]
  ds_read_b128 v[112:115], v4 offset:2368
  ds_read_b128 v[116:119], v5 offset:2960
  ds_read_b128 v[120:123], v5 offset:400
  ds_read_b128 v[124:127], v4 offset:320
  v_mfma_f32_32x32x16_f16 v[64:79], v[48:51], v[56:59], v[64:79]
  buffer_load_dwordx4 a[168:171], v2, s[48:51], s46 offen offset:2048 sc1
  v_mfma_f32_32x32x16_f16 v[80:95], v[60:63], v[56:59], v[80:95]
  buffer_load_dwordx4 a[172:175], v2, s[48:51], s46 offen offset:3072 sc1
  s_waitcnt lgkmcnt(4)
  v_mfma_f32_32x32x16_f16 v[80:95], v[96:99], v[100:103], v[80:95]
  ds_read_b128 v[48:51], v4 offset:2304
  ds_read_b128 v[52:55], v5 offset:2880
  ds_read_b128 v[56:59], v5 offset:320
  ds_read_b128 v[60:63], v4 offset:256
  v_mfma_f32_32x32x16_f16 v[64:79], v[96:99], v[104:107], v[64:79]
  s_add_u32 s46, s89, 12288
  buffer_load_dwordx4 a[176:179], v2, s[48:51], s46 offen offset:0 sc1
  v_mfma_f32_32x32x16_f16 v[80:95], v[108:111], v[104:107], v[80:95]
  s_waitcnt lgkmcnt(4)
  v_mfma_f32_32x32x16_f16 v[80:95], v[112:115], v[116:119], v[80:95]
  ds_read_b128 v[96:99], v4 offset:2240
  ds_read_b128 v[100:103], v5 offset:2800
  ds_read_b128 v[104:107], v5 offset:240
  ds_read_b128 v[108:111], v4 offset:192
  v_mfma_f32_32x32x16_f16 v[64:79], v[112:115], v[120:123], v[64:79]
  buffer_load_dwordx4 a[180:183], v2, s[48:51], s46 offen offset:1024 sc1
  v_mfma_f32_32x32x16_f16 v[80:95], v[124:127], v[120:123], v[80:95]
  s_waitcnt lgkmcnt(4)
  v_mfma_f32_32x32x16_f16 v[80:95], v[48:51], v[52:55], v[80:95]
  ds_read_b128 v[112:115], v4 offset:2176
  ds_read_b128 v[116:119], v5 offset:2720
  ds_read_b128 v[120:123], v5 offset:160
  ds_read_b128 v[124:127], v4 offset:128
  v_mfma_f32_32x32x16_f16 v[64:79], v[48:51], v[56:59], v[64:79]
  buffer_load_dwordx4 a[184:187], v2, s[48:51], s46 offen offset:2048 sc1
  v_mfma_f32_32x32x16_f16 v[80:95], v[60:63], v[56:59], v[80:95]
  s_waitcnt lgkmcnt(4)
  v_mfma_f32_32x32x16_f16 v[80:95], v[96:99], v[100:103], v[80:95]
  ds_read_b128 v[48:51], v4 offset:2112
  ds_read_b128 v[52:55], v5 offset:2640
  ds_read_b128 v[56:59], v5 offset:80
  ds_read_b128 v[60:63], v4 offset:64
  v_mfma_f32_32x32x16_f16 v[64:79], v[96:99], v[104:107], v[64:79]
  buffer_load_dwordx4 a[188:191], v2, s[48:51], s46 offen offset:3072 sc1
  v_mfma_f32_32x32x16_f16 v[80:95], v[108:111], v[104:107], v[80:95]
  s_add_u32 s46, s89, 16384
  buffer_load_dwordx4 a[192:195], v2, s[48:51], s46 offen offset:0 sc1
  s_waitcnt lgkmcnt(4)
  v_mfma_f32_32x32x16_f16 v[80:95], v[112:115], v[116:119], v[80:95]
  ds_read_b128 v[96:99], v4 offset:2048
  ds_read_b128 v[100:103], v5 offset:2560
  ds_read_b128 v[104:107], v5 offset:0
  ds_read_b128 v[108:111], v4 offset:0
  v_mfma_f32_32x32x16_f16 v[64:79], v[112:115], v[120:123], v[64:79]
  buffer_load_dwordx4 a[196:199], v2, s[48:51], s46 offen offset:1024 sc1
  v_mfma_f32_32x32x16_f16 v[80:95], v[124:127], v[120:123], v[80:95]
  s_waitcnt lgkmcnt(4)
  v_mfma_f32_32x32x16_f16 v[80:95], v[48:51], v[52:55], v[80:95]
  v_mfma_f32_32x32x16_f16 v[64:79], v[48:51], v[56:59], v[64:79]
  buffer_load_dwordx4 a[200:203], v2, s[48:51], s46 offen offset:2048 sc1
  v_mfma_f32_32x32x16_f16 v[80:95], v[60:63], v[56:59], v[80:95]
  s_waitcnt lgkmcnt(0)
  v_mfma_f32_32x32x16_f16 v[80:95], v[96:99], v[100:103], v[80:95]
  v_mfma_f32_32x32x16_f16 v[64:79], v[96:99], v[104:107], v[64:79]
  buffer_load_dwordx4 a[204:207], v2, s[48:51], s46 offen offset:3072 sc1
  v_mfma_f32_32x32x16_f16 v[80:95], v[108:111], v[104:107], v[80:95]
s_nop 9
  ds_write_b128 v19, v[64:67] offset:0
  ds_write_b128 v19, v[68:71] offset:32
  ds_write_b128 v19, v[72:75] offset:64
  ds_write_b128 v19, v[76:79] offset:96
  ds_write_b128 v19, v[80:83] offset:4608
  ds_write_b128 v19, v[84:87] offset:4640
  ds_write_b128 v19, v[88:91] offset:4672
  ds_write_b128 v19, v[92:95] offset:4704
  v_lshlrev_b32 v96, 16, v8
  v_and_b32 v97, s69, v8
  s_add_u32 s46, s89, 20480
  buffer_load_dwordx4 a[208:211], v2, s[48:51], s46 offen offset:0 sc1
  v_lshlrev_b32 v98, 16, v9
  v_and_b32 v99, s69, v9
  v_lshlrev_b32 v100, 16, v10
  v_and_b32 v101, s69, v10
  v_lshlrev_b32 v102, 16, v11
  v_and_b32 v103, s69, v11
  v_lshlrev_b32 v104, 16, v12
  v_and_b32 v105, s69, v12
  buffer_load_dwordx4 a[212:215], v2, s[48:51], s46 offen offset:1024 sc1
  v_lshlrev_b32 v106, 16, v13
  v_and_b32 v107, s69, v13
  v_lshlrev_b32 v108, 16, v14
  v_and_b32 v109, s69, v14
  v_lshlrev_b32 v110, 16, v15
  v_and_b32 v111, s69, v15
  s_waitcnt lgkmcnt(0)
  s_barrier
  ds_read_b128 v[64:67], v20 offset:0
  ds_read_b128 v[68:71], v20 offset:16
  ds_read_b128 v[72:75], v20 offset:9216
  ds_read_b128 v[76:79], v20 offset:9232
  ds_read_b128 v[80:83], v20 offset:18432
  ds_read_b128 v[84:87], v20 offset:18448
  ds_read_b128 v[88:91], v20 offset:27648
  ds_read_b128 v[92:95], v20 offset:27664
  s_waitcnt vmcnt(22)
  s_waitcnt lgkmcnt(4)
  v_pk_add_f32 v[64:65], v[64:65], v[72:73]
  v_pk_add_f32 v[66:67], v[66:67], v[74:75]
  v_pk_add_f32 v[68:69], v[68:69], v[76:77]
  v_pk_add_f32 v[70:71], v[70:71], v[78:79]
  v_pk_mul_f32 v[64:65], v[64:65], v[24:25] op_sel:[0,0] op_sel_hi:[1,0]
  v_pk_mul_f32 v[66:67], v[66:67], v[24:25] op_sel:[0,0] op_sel_hi:[1,0]
  v_pk_mul_f32 v[68:69], v[68:69], v[24:25] op_sel:[0,0] op_sel_hi:[1,0]
  v_pk_mul_f32 v[70:71], v[70:71], v[24:25] op_sel:[0,0] op_sel_hi:[1,0]
  v_cvt_pk_bf16_f32 v72, v64, v65
  v_cvt_pk_bf16_f32 v73, v66, v67
  v_cvt_pk_bf16_f32 v74, v68, v69
  v_cvt_pk_bf16_f32 v75, v70, v71
  v_lshlrev_b32 v64, 16, v72
  v_and_b32 v65, s69, v72
  v_lshlrev_b32 v66, 16, v73
  v_and_b32 v67, s69, v73
  v_lshlrev_b32 v68, 16, v74
  v_and_b32 v69, s69, v74
  v_lshlrev_b32 v70, 16, v75
  v_and_b32 v71, s69, v75
  v_pk_add_f32 v[64:65], v[64:65], v[32:33]
  v_pk_add_f32 v[66:67], v[66:67], v[34:35]
  v_pk_add_f32 v[68:69], v[68:69], v[36:37]
  v_pk_add_f32 v[70:71], v[70:71], v[38:39]
  v_cvt_pk_bf16_f32 v72, v64, v65
  v_cvt_pk_bf16_f32 v73, v66, v67
  v_cvt_pk_bf16_f32 v74, v68, v69
  v_cvt_pk_bf16_f32 v75, v70, v71
  v_lshlrev_b32 v64, 16, v72
  v_and_b32 v65, s69, v72
  v_lshlrev_b32 v66, 16, v73
  v_and_b32 v67, s69, v73
  v_lshlrev_b32 v68, 16, v74
  v_and_b32 v69, s69, v74
  v_lshlrev_b32 v70, 16, v75
  v_and_b32 v71, s69, v75
  v_pk_add_f32 v[64:65], v[64:65], v[96:97]
  v_pk_add_f32 v[66:67], v[66:67], v[98:99]
  v_pk_add_f32 v[68:69], v[68:69], v[100:101]
  v_pk_add_f32 v[70:71], v[70:71], v[102:103]
  v_cvt_pk_bf16_f32 v72, v64, v65
  v_cvt_pk_bf16_f32 v73, v66, v67
  v_cvt_pk_bf16_f32 v74, v68, v69
  v_cvt_pk_bf16_f32 v75, v70, v71
  buffer_store_dwordx4 v[72:75], v22, s[48:51], s10 offen offset:0 sc1
  s_waitcnt lgkmcnt(0)
  v_pk_add_f32 v[80:81], v[80:81], v[88:89]
  v_pk_add_f32 v[82:83], v[82:83], v[90:91]
  v_pk_add_f32 v[84:85], v[84:85], v[92:93]
  v_pk_add_f32 v[86:87], v[86:87], v[94:95]
  v_pk_mul_f32 v[80:81], v[80:81], v[24:25] op_sel:[0,1] op_sel_hi:[1,1]
  v_pk_mul_f32 v[82:83], v[82:83], v[24:25] op_sel:[0,1] op_sel_hi:[1,1]
  v_pk_mul_f32 v[84:85], v[84:85], v[24:25] op_sel:[0,1] op_sel_hi:[1,1]
  v_pk_mul_f32 v[86:87], v[86:87], v[24:25] op_sel:[0,1] op_sel_hi:[1,1]
  v_cvt_pk_bf16_f32 v88, v80, v81
  v_cvt_pk_bf16_f32 v89, v82, v83
  v_cvt_pk_bf16_f32 v90, v84, v85
  v_cvt_pk_bf16_f32 v91, v86, v87
  v_lshlrev_b32 v80, 16, v88
  v_and_b32 v81, s69, v88
  v_lshlrev_b32 v82, 16, v89
  v_and_b32 v83, s69, v89
  v_lshlrev_b32 v84, 16, v90
  v_and_b32 v85, s69, v90
  v_lshlrev_b32 v86, 16, v91
  v_and_b32 v87, s69, v91
  v_pk_add_f32 v[80:81], v[80:81], v[40:41]
  v_pk_add_f32 v[82:83], v[82:83], v[42:43]
  v_pk_add_f32 v[84:85], v[84:85], v[44:45]
  v_pk_add_f32 v[86:87], v[86:87], v[46:47]
  v_cvt_pk_bf16_f32 v88, v80, v81
  v_cvt_pk_bf16_f32 v89, v82, v83
  v_cvt_pk_bf16_f32 v90, v84, v85
  v_cvt_pk_bf16_f32 v91, v86, v87
  v_lshlrev_b32 v80, 16, v88
  v_and_b32 v81, s69, v88
  v_lshlrev_b32 v82, 16, v89
  v_and_b32 v83, s69, v89
  v_lshlrev_b32 v84, 16, v90
  v_and_b32 v85, s69, v90
  v_lshlrev_b32 v86, 16, v91
  v_and_b32 v87, s69, v91
  v_pk_add_f32 v[80:81], v[80:81], v[104:105]
  v_pk_add_f32 v[82:83], v[82:83], v[106:107]
  v_pk_add_f32 v[84:85], v[84:85], v[108:109]
  v_pk_add_f32 v[86:87], v[86:87], v[110:111]
  v_cvt_pk_bf16_f32 v88, v80, v81
  v_cvt_pk_bf16_f32 v89, v82, v83
  v_cvt_pk_bf16_f32 v90, v84, v85
  v_cvt_pk_bf16_f32 v91, v86, v87
  buffer_store_dwordx4 v[88:91], v22, s[48:51], s10 offen offset:64 sc1
  v_mov_b32 v112, s68
  v_mov_b32 v113, s68
  v_mov_b32 v114, s68
  v_mov_b32 v115, s68
s_nop 1
  v_mfma_f32_32x32x16_bf16 v[96:111], v[112:115], a[0:3], 0
  v_mfma_f32_32x32x16_bf16 v[96:111], v[112:115], a[4:7], v[96:111]
  v_mfma_f32_32x32x16_bf16 v[96:111], v[112:115], a[8:11], v[96:111]
  v_mfma_f32_32x32x16_bf16 v[96:111], v[112:115], a[12:15], v[96:111]
  v_mfma_f32_32x32x16_bf16 v[96:111], v[112:115], a[16:19], v[96:111]
  v_mfma_f32_32x32x16_bf16 v[96:111], v[112:115], a[20:23], v[96:111]
  v_mfma_f32_32x32x16_bf16 v[96:111], v[112:115], a[24:27], v[96:111]
  v_mfma_f32_32x32x16_bf16 v[96:111], v[112:115], a[28:31], v[96:111]
  v_mfma_f32_32x32x16_bf16 v[96:111], v[112:115], a[32:35], v[96:111]
  v_mfma_f32_32x32x16_bf16 v[96:111], v[112:115], a[36:39], v[96:111]
  v_mfma_f32_32x32x16_bf16 v[96:111], v[112:115], a[40:43], v[96:111]
  s_waitcnt vmcnt(0)
  s_barrier
  s_cmp_lg_u32 s3, 0
  s_cbranch_scc1 Q1
  s_mov_b64 exec, 1
  buffer_store_dword v6, off, s[48:51], s11 sc1
  s_mov_b64 exec, -1
Q1:
  v_mfma_f32_32x32x16_bf16 v[96:111], v[112:115], a[44:47], v[96:111]
  buffer_load_dwordx4 a[216:219], v2, s[48:51], s46 offen offset:2048 sc1
  v_mfma_f32_32x32x16_bf16 v[96:111], v[112:115], a[48:51], v[96:111]
  v_mfma_f32_32x32x16_bf16 v[96:111], v[112:115], a[52:55], v[96:111]
  buffer_load_dwordx4 a[220:223], v2, s[48:51], s46 offen offset:3072 sc1
  v_mfma_f32_32x32x16_bf16 v[96:111], v[112:115], a[56:59], v[96:111]
  v_mfma_f32_32x32x16_bf16 v[96:111], v[112:115], a[60:63], v[96:111]
  s_add_u32 s46, s89, 24576
  buffer_load_dwordx4 a[224:227], v2, s[48:51], s46 offen offset:0 sc1
  v_mfma_f32_32x32x16_bf16 v[96:111], v[112:115], a[64:67], v[96:111]
  v_mfma_f32_32x32x16_bf16 v[96:111], v[112:115], a[68:71], v[96:111]
  buffer_load_dwordx4 a[228:231], v2, s[48:51], s46 offen offset:1024 sc1
  v_mfma_f32_32x32x16_bf16 v[96:111], v[112:115], a[72:75], v[96:111]
  v_mfma_f32_32x32x16_bf16 v[96:111], v[112:115], a[76:79], v[96:111]
  v_mfma_f32_32x32x16_bf16 v[96:111], v[112:115], a[80:83], v[96:111]
  v_mfma_f32_32x32x16_bf16 v[96:111], v[112:115], a[84:87], v[96:111]
  v_mfma_f32_32x32x16_bf16 v[96:111], v[112:115], a[88:91], v[96:111]
  v_mfma_f32_32x32x16_bf16 v[96:111], v[112:115], a[92:95], v[96:111]
  v_mfma_f32_32x32x16_bf16 v[96:111], v[112:115], a[96:99], v[96:111]
  v_mfma_f32_32x32x16_bf16 v[96:111], v[112:115], a[100:103], v[96:111]
  v_mfma_f32_32x32x16_bf16 v[96:111], v[112:115], a[104:107], v[96:111]
  v_mfma_f32_32x32x16_bf16 v[96:111], v[112:115], a[108:111], v[96:111]
  v_mfma_f32_32x32x16_bf16 v[96:111], v[112:115], a[112:115], v[96:111]
  v_mfma_f32_32x32x16_bf16 v[96:111], v[112:115], a[116:119], v[96:111]
  v_mfma_f32_32x32x16_bf16 v[96:111], v[112:115], a[120:123], v[96:111]
  v_mfma_f32_32x32x16_bf16 v[96:111], v[112:115], a[124:127], v[96:111]
s_nop 11
  v_cvt_pk_bf16_f32 v97, v96, v96
  v_and_b32 v97, s69, v97
  v_sub_f32 v96, v96, v97
  v_cvt_pk_bf16_f32 v98, v96, v96
  v_and_b32 v98, s69, v98
  v_sub_f32 v99, v96, v98
  v_cvt_pk_bf16_f32 v8, v97, v98
  v_cvt_pk_bf16_f32 v9, v99, v97
  v_cvt_pk_bf16_f32 v10, v98, 0
  v_mov_b32 v11, 0
  s_lshl_b32 s8, s71, 15
  s_lshl_b32 s9, s3, 13
  s_add_u32 s8, s8, s9
  s_add_u32 s8, s8, 1048576
  v_add_u32 v4, s9, v3
  s_lshl_b32 s10, s72, 2
  s_add_u32 s10, s10, s3
  s_lshl_b32 s11, s10, 11
  v_add_u32 v5, s11, v3
  v_lshlrev_b32 v6, 3, v0
  v_add_u32 v6, 160512, v6
  v_and_b32 v22, 31, v1
  v_lshrrev_b32 v24, 5, v1
  v_lshlrev_b32 v23, 4, v22
  v_lshl_add_u32 v23, v24, 15, v23
  v_lshlrev_b32 v22, 3, v22
  v_add_u32 v22, 160512, v22
  v_cmp_gt_u32 s[14:15], 32, v1
  s_lshl_b32 s10, s10, 17
  s_lshl_b32 s12, s71, 9
  s_add_u32 s10, s10, s12
  s_add_u32 s96, s10, 3145728
  s_add_u32 s97, s96, 65536
  s_lshl_b32 s12, s71, 15
  s_add_u32 s98, s12, s11
  s_lshl_b32 s99, s2, 7
  v_mov_b32 v47, 0
  s_mov_b32 s13, 32768
  s_cmp_lg_u32 s3, 0
  s_cbranch_scc1 P2_done
  s_mov_b32 s6, 30000
  v_lshlrev_b32 v28, 7, v1
  s_mov_b32 s40, 4
  s_mov_b32 s41, 8196
  s_mov_b32 s42, 16388
  s_mov_b32 s43, 24580
P2_loop:
  buffer_load_dword v24, v28, s[48:51], s40 offen sc1
  buffer_load_dword v25, v28, s[48:51], s41 offen sc1
  buffer_load_dword v26, v28, s[48:51], s42 offen sc1
  buffer_load_dword v27, v28, s[48:51], s43 offen sc1
  s_sub_u32 s6, s6, 1
  s_cbranch_scc1 P2_done
  s_waitcnt vmcnt(0)
  v_and_b32 v24, v24, v25
  v_and_b32 v26, v26, v27
  v_and_b32 v24, v24, v26
  v_cmp_ne_u32 vcc, 1, v24
s_nop 4
  s_cbranch_vccnz P2_loop
P2_done:
  s_barrier
  s_add_u32 m0, s9, 0
  s_add_u32 s10, s8, 0
  buffer_load_dwordx4 v2, s[48:51], s10 offen offset:0 sc1 lds
  buffer_load_dwordx4 v2, s[48:51], s10 offen offset:1024 sc1 lds
  buffer_load_dwordx4 v2, s[48:51], s10 offen offset:2048 sc1 lds
  buffer_load_dwordx4 v2, s[48:51], s10 offen offset:3072 sc1 lds
  s_add_u32 m0, s9, 4096
  s_add_u32 s10, s8, 4096
  buffer_load_dwordx4 v2, s[48:51], s10 offen offset:0 sc1 lds
  buffer_load_dwordx4 v2, s[48:51], s10 offen offset:1024 sc1 lds
  buffer_load_dwordx4 v2, s[48:51], s10 offen offset:2048 sc1 lds
  buffer_load_dwordx4 v2, s[48:51], s10 offen offset:3072 sc1 lds
  buffer_load_dwordx4 a[232:235], v2, s[48:51], s46 offen offset:2048 sc1
  buffer_load_dwordx4 a[236:239], v2, s[48:51], s46 offen offset:3072 sc1
  s_add_u32 s46, s89, 28672
  buffer_load_dwordx4 a[240:243], v2, s[48:51], s46 offen offset:0 sc1
  buffer_load_dwordx4 a[244:247], v2, s[48:51], s46 offen offset:1024 sc1
  buffer_load_dwordx4 a[248:251], v2, s[48:51], s46 offen offset:2048 sc1
  buffer_load_dwordx4 a[252:255], v2, s[48:51], s46 offen offset:3072 sc1
  s_add_u32 s46, s32, 0
  s_and_b32 s46, s46, 0x7fff
  s_add_u32 s46, s46, s90
  buffer_load_dwordx4 v[128:131], v2, s[48:51], s46 offen offset:0 sc1
  buffer_load_dwordx4 v[132:135], v2, s[48:51], s46 offen offset:1024 sc1
  s_waitcnt vmcnt(8)
  ds_read_b64_tr_b16 v[96:97], v4 offset:0
  ds_read_b64_tr_b16 v[98:99], v4 offset:512
  ds_read_b64_tr_b16 v[100:101], v4 offset:1024
  ds_read_b64_tr_b16 v[102:103], v4 offset:1536
  ds_read_b64_tr_b16 v[104:105], v4 offset:2048
  ds_read_b64_tr_b16 v[106:107], v4 offset:2560
  ds_read_b64_tr_b16 v[108:109], v4 offset:3072
  ds_read_b64_tr_b16 v[110:111], v4 offset:3584
  ds_read_b64_tr_b16 v[112:113], v4 offset:4096
  ds_read_b64_tr_b16 v[114:115], v4 offset:4608
  ds_read_b64_tr_b16 v[116:117], v4 offset:5120
  ds_read_b64_tr_b16 v[118:119], v4 offset:5632
  ds_read_b64_tr_b16 v[120:121], v4 offset:6144
  ds_read_b64_tr_b16 v[122:123], v4 offset:6656
  ds_read_b64_tr_b16 v[124:125], v4 offset:7168
  ds_read_b64_tr_b16 v[126:127], v4 offset:7680
  s_waitcnt lgkmcnt(14)
  v_dot2_f32_bf16 v48, v96, v96, 0
  v_dot2_f32_bf16 v52, v96, s68, 0
  v_dot2_f32_bf16 v49, v97, v97, 0
  v_dot2_f32_bf16 v53, v97, s68, 0
  v_dot2_f32_bf16 v50, v98, v98, 0
  v_dot2_f32_bf16 v54, v98, s68, 0
  v_dot2_f32_bf16 v51, v99, v99, 0
  v_dot2_f32_bf16 v55, v99, s68, 0
  s_waitcnt lgkmcnt(12)
  v_dot2_f32_bf16 v48, v100, v100, v48
  v_dot2_f32_bf16 v52, v100, s68, v52
  v_dot2_f32_bf16 v49, v101, v101, v49
  v_dot2_f32_bf16 v53, v101, s68, v53
  v_dot2_f32_bf16 v50, v102, v102, v50
  v_dot2_f32_bf16 v54, v102, s68, v54
  v_dot2_f32_bf16 v51, v103, v103, v51
  v_dot2_f32_bf16 v55, v103, s68, v55
  s_waitcnt lgkmcnt(10)
  v_dot2_f32_bf16 v48, v104, v104, v48
  v_dot2_f32_bf16 v52, v104, s68, v52
  v_dot2_f32_bf16 v49, v105, v105, v49
  v_dot2_f32_bf16 v53, v105, s68, v53
  v_dot2_f32_bf16 v50, v106, v106, v50
  v_dot2_f32_bf16 v54, v106, s68, v54
  v_dot2_f32_bf16 v51, v107, v107, v51
  v_dot2_f32_bf16 v55, v107, s68, v55
  s_waitcnt lgkmcnt(8)
  v_dot2_f32_bf16 v48, v108, v108, v48
  v_dot2_f32_bf16 v52, v108, s68, v52
  v_dot2_f32_bf16 v49, v109, v109, v49
  v_dot2_f32_bf16 v53, v109, s68, v53
  v_dot2_f32_bf16 v50, v110, v110, v50
  v_dot2_f32_bf16 v54, v110, s68, v54
  v_dot2_f32_bf16 v51, v111, v111, v51
  v_dot2_f32_bf16 v55, v111, s68, v55
  s_waitcnt lgkmcnt(6)
  v_dot2_f32_bf16 v48, v112, v112, v48
  v_dot2_f32_bf16 v52, v112, s68, v52
  v_dot2_f32_bf16 v49, v113, v113, v49
  v_dot2_f32_bf16 v53, v113, s68, v53
  v_dot2_f32_bf16 v50, v114, v114, v50
  v_dot2_f32_bf16 v54, v114, s68, v54
  v_dot2_f32_bf16 v51, v115, v115, v51
  v_dot2_f32_bf16 v55, v115, s68, v55
  s_waitcnt lgkmcnt(4)
  v_dot2_f32_bf16 v48, v116, v116, v48
  v_dot2_f32_bf16 v52, v116, s68, v52
  v_dot2_f32_bf16 v49, v117, v117, v49
  v_dot2_f32_bf16 v53, v117, s68, v53
  v_dot2_f32_bf16 v50, v118, v118, v50
  v_dot2_f32_bf16 v54, v118, s68, v54
  v_dot2_f32_bf16 v51, v119, v119, v51
  v_dot2_f32_bf16 v55, v119, s68, v55
  s_waitcnt lgkmcnt(2)
  v_dot2_f32_bf16 v48, v120, v120, v48
  v_dot2_f32_bf16 v52, v120, s68, v52
  v_dot2_f32_bf16 v49, v121, v121, v49
  v_dot2_f32_bf16 v53, v121, s68, v53
  v_dot2_f32_bf16 v50, v122, v122, v50
  v_dot2_f32_bf16 v54, v122, s68, v54
  v_dot2_f32_bf16 v51, v123, v123, v51
  v_dot2_f32_bf16 v55, v123, s68, v55
  s_waitcnt lgkmcnt(0)
  v_dot2_f32_bf16 v48, v124, v124, v48
  v_dot2_f32_bf16 v52, v124, s68, v52
  v_dot2_f32_bf16 v49, v125, v125, v49
  v_dot2_f32_bf16 v53, v125, s68, v53
  v_dot2_f32_bf16 v50, v126, v126, v50
  v_dot2_f32_bf16 v54, v126, s68, v54
  v_dot2_f32_bf16 v51, v127, v127, v51
  v_dot2_f32_bf16 v55, v127, s68, v55
s_nop 1
  v_pk_add_f32 v[48:49], v[48:49], v[50:51]
  v_pk_add_f32 v[52:53], v[52:53], v[54:55]
  v_add_f32 v25, v48, v49
  v_add_f32 v24, v52, v53
  ds_write_b64 v6, v[24:25]
  s_waitcnt lgkmcnt(0)
  s_barrier
  ds_read_b64_tr_b16 v[84:85], v3 offset:0
  ds_read_b64_tr_b16 v[86:87], v3 offset:512
  ds_read_b64_tr_b16 v[88:89], v3 offset:1024
  ds_read_b64_tr_b16 v[90:91], v3 offset:1536
  ds_read_b64_tr_b16 v[92:93], v3 offset:2048
  ds_read_b64_tr_b16 v[94:95], v3 offset:2560
  s_waitcnt lgkmcnt(4)
  v_mfma_f32_32x32x16_bf16 v[64:79], a[0:3], v[84:87], 0
  ds_read_b64_tr_b16 v[40:41], v3 offset:3072
  ds_read_b64_tr_b16 v[42:43], v3 offset:3584
  buffer_load_dwordx4 v[136:139], v2, s[48:51], s46 offen offset:2048 sc1
  ds_read_b64 v[96:97], v22 offset:0
  ds_read_b64 v[98:99], v22 offset:256
  s_waitcnt lgkmcnt(6)
  v_mfma_f32_32x32x16_bf16 v[64:79], a[4:7], v[88:91], v[64:79]
  ds_read_b64_tr_b16 v[84:85], v3 offset:4096
  ds_read_b64_tr_b16 v[86:87], v3 offset:4608
  ds_read_b64 v[100:101], v22 offset:512
  ds_read_b64 v[102:103], v22 offset:768
  s_waitcnt lgkmcnt(8)
  v_mfma_f32_32x32x16_bf16 v[64:79], a[8:11], v[92:95], v[64:79]
  ds_read_b64_tr_b16 v[88:89], v3 offset:5120
  ds_read_b64_tr_b16 v[90:91], v3 offset:5632
  buffer_load_dwordx4 v[140:143], v2, s[48:51], s46 offen offset:3072 sc1
  ds_read_b64 v[104:105], v22 offset:1024
  ds_read_b64 v[106:107], v22 offset:1280
  s_waitcnt lgkmcnt(10)
  v_mfma_f32_32x32x16_bf16 v[64:79], a[12:15], v[40:43], v[64:79]
  ds_read_b64_tr_b16 v[92:93], v3 offset:6144
  ds_read_b64_tr_b16 v[94:95], v3 offset:6656
  ds_read_b64 v[108:109], v22 offset:1536
  ds_read_b64 v[110:111], v22 offset:1792
  s_waitcnt lgkmcnt(10)
  v_mfma_f32_32x32x16_bf16 v[64:79], a[16:19], v[84:87], v[64:79]
  ds_read_b64_tr_b16 v[40:41], v3 offset:7168
  ds_read_b64_tr_b16 v[42:43], v3 offset:7680
  s_add_u32 s46, s32, 4096
  s_and_b32 s46, s46, 0x7fff
  s_add_u32 s46, s46, s90
  buffer_load_dwordx4 v[144:147], v2, s[48:51], s46 offen offset:0 sc1
  ds_read_b64_tr_b16 v[12:13], v5 offset:0
  ds_read_b64_tr_b16 v[14:15], v5 offset:512
  s_waitcnt lgkmcnt(10)
  v_mfma_f32_32x32x16_bf16 v[64:79], a[20:23], v[88:91], v[64:79]
  ds_read_b64_tr_b16 v[84:85], v3 offset:8192
  ds_read_b64_tr_b16 v[86:87], v3 offset:8704
  ds_read_b64_tr_b16 v[16:17], v5 offset:1024
  ds_read_b64_tr_b16 v[18:19], v5 offset:1536
  s_waitcnt lgkmcnt(10)
  v_mfma_f32_32x32x16_bf16 v[64:79], a[24:27], v[92:95], v[64:79]
  ds_read_b64_tr_b16 v[88:89], v3 offset:9216
  ds_read_b64_tr_b16 v[90:91], v3 offset:9728
  buffer_load_dwordx4 v[148:151], v2, s[48:51], s46 offen offset:1024 sc1
  s_waitcnt lgkmcnt(10)
  v_add_f32 v96, v96, v104
  s_waitcnt lgkmcnt(8)
  v_mfma_f32_32x32x16_bf16 v[64:79], a[28:31], v[40:43], v[64:79]
  ds_read_b64_tr_b16 v[92:93], v3 offset:10240
  ds_read_b64_tr_b16 v[94:95], v3 offset:10752
  v_add_f32 v97, v97, v105
  v_add_f32 v98, v98, v106
  s_waitcnt lgkmcnt(6)
  v_mfma_f32_32x32x16_bf16 v[64:79], a[32:35], v[84:87], v[64:79]
  ds_read_b64_tr_b16 v[40:41], v3 offset:11264
  ds_read_b64_tr_b16 v[42:43], v3 offset:11776
  buffer_load_dwordx4 v[152:155], v2, s[48:51], s46 offen offset:2048 sc1
  v_add_f32 v99, v99, v107
  v_add_f32 v100, v100, v108
  v_add_f32 v101, v101, v109
  s_waitcnt lgkmcnt(4)
  v_mfma_f32_32x32x16_bf16 v[64:79], a[36:39], v[88:91], v[64:79]
  ds_read_b64_tr_b16 v[84:85], v3 offset:12288
  ds_read_b64_tr_b16 v[86:87], v3 offset:12800
  v_add_f32 v102, v102, v110
  v_add_f32 v103, v103, v111
  v_add_f32 v96, v96, v100
  s_waitcnt lgkmcnt(4)
  v_mfma_f32_32x32x16_bf16 v[64:79], a[40:43], v[92:95], v[64:79]
  ds_read_b64_tr_b16 v[88:89], v3 offset:13312
  ds_read_b64_tr_b16 v[90:91], v3 offset:13824
  buffer_load_dwordx4 v[156:159], v2, s[48:51], s46 offen offset:3072 sc1
  v_add_f32 v97, v97, v101
  v_add_f32 v98, v98, v102
  v_add_f32 v99, v99, v103
  s_waitcnt lgkmcnt(4)
  v_mfma_f32_32x32x16_bf16 v[64:79], a[44:47], v[40:43], v[64:79]
  ds_read_b64_tr_b16 v[92:93], v3 offset:14336
  ds_read_b64_tr_b16 v[94:95], v3 offset:14848
  v_add_f32 v96, v96, v98
  v_add_f32 v97, v97, v99
  v_mul_f32 v96, 0x3b000000, v96
  s_waitcnt lgkmcnt(4)
  v_mfma_f32_32x32x16_bf16 v[64:79], a[48:51], v[84:87], v[64:79]
  ds_read_b64_tr_b16 v[40:41], v3 offset:15360
  ds_read_b64_tr_b16 v[42:43], v3 offset:15872
  s_add_u32 s46, s32, 8192
  s_and_b32 s46, s46, 0x7fff
  s_add_u32 s46, s46, s90
  buffer_load_dwordx4 v[160:163], v2, s[48:51], s46 offen offset:0 sc1
  v_mul_f32 v97, 0x3b000000, v97
  v_fma_f32 v97, -v96, v96, v97
  v_max_f32 v97, 0, v97
  s_waitcnt lgkmcnt(4)
  v_mfma_f32_32x32x16_bf16 v[64:79], a[52:55], v[88:91], v[64:79]
  ds_read_b64_tr_b16 v[84:85], v3 offset:16384
  ds_read_b64_tr_b16 v[86:87], v3 offset:16896
  v_cvt_pk_bf16_f32 v27, v96, v97
  v_lshlrev_b32 v20, 16, v27
  v_and_b32 v27, s69, v27
  s_waitcnt lgkmcnt(4)
  v_mfma_f32_32x32x16_bf16 v[64:79], a[56:59], v[92:95], v[64:79]
  ds_read_b64_tr_b16 v[88:89], v3 offset:17408
  ds_read_b64_tr_b16 v[90:91], v3 offset:17920
  buffer_load_dwordx4 v[164:167], v2, s[48:51], s46 offen offset:1024 sc1
  v_add_f32 v27, 0x3727c5ac, v27
  v_cvt_pk_bf16_f32 v27, v27, v27
  v_and_b32 v27, s69, v27
  s_waitcnt lgkmcnt(4)
  v_mfma_f32_32x32x16_bf16 v[64:79], a[60:63], v[40:43], v[64:79]
  ds_read_b64_tr_b16 v[92:93], v3 offset:18432
  ds_read_b64_tr_b16 v[94:95], v3 offset:18944
  v_sqrt_f32 v27, v27
s_nop 0
  v_cvt_pk_bf16_f32 v27, v27, v27
  v_and_b32 v26, s69, v27
  s_waitcnt lgkmcnt(4)
  v_mfma_f32_32x32x16_bf16 v[64:79], a[64:67], v[84:87], v[64:79]
  ds_read_b64_tr_b16 v[40:41], v3 offset:19456
  ds_read_b64_tr_b16 v[42:43], v3 offset:19968
  buffer_load_dwordx4 v[168:171], v2, s[48:51], s46 offen offset:2048 sc1
  v_rcp_f32 v21, v26
  v_sub_f32 v28, v96, v20
  v_mul_f32 v28, v28, v21
  s_waitcnt lgkmcnt(4)
  v_mfma_f32_32x32x16_bf16 v[64:79], a[68:71], v[88:91], v[64:79]
  ds_read_b64_tr_b16 v[84:85], v3 offset:20480
  ds_read_b64_tr_b16 v[86:87], v3 offset:20992
  v_mul_f32 v27, v97, v21
  v_mul_f32 v27, v27, v21
  v_cvt_pk_bf16_f32 v27, v28, v27
  s_waitcnt lgkmcnt(4)
  v_mfma_f32_32x32x16_bf16 v[64:79], a[72:75], v[92:95], v[64:79]
  ds_read_b64_tr_b16 v[88:89], v3 offset:21504
  ds_read_b64_tr_b16 v[90:91], v3 offset:22016
  buffer_load_dwordx4 v[172:175], v2, s[48:51], s46 offen offset:3072 sc1
  v_lshlrev_b32 v28, 16, v27
  v_and_b32 v27, s69, v27
  v_mul_f32 v28, v28, v26
  s_waitcnt lgkmcnt(4)
  v_mfma_f32_32x32x16_bf16 v[64:79], a[76:79], v[40:43], v[64:79]
  ds_read_b64_tr_b16 v[92:93], v3 offset:22528
  ds_read_b64_tr_b16 v[94:95], v3 offset:23040
  v_cvt_pk_bf16_f32 v44, -v20, -v20
  v_cvt_pk_bf16_f32 v45, -v20, -v28
  v_cvt_pk_bf16_f32 v46, -v28, 0
  s_waitcnt lgkmcnt(4)
  v_mfma_f32_32x32x16_bf16 v[64:79], a[80:83], v[84:87], v[64:79]
  ds_read_b64_tr_b16 v[40:41], v3 offset:23552
  ds_read_b64_tr_b16 v[42:43], v3 offset:24064
  s_add_u32 s46, s32, 12288
  s_and_b32 s46, s46, 0x7fff
  s_add_u32 s46, s46, s90
  buffer_load_dwordx4 v[176:179], v2, s[48:51], s46 offen offset:0 sc1
  v_cndmask_b32 v44, 0, v44, s[14:15]
  v_cndmask_b32 v45, 0, v45, s[14:15]
  v_cndmask_b32 v46, 0, v46, s[14:15]
  s_waitcnt lgkmcnt(4)
  v_mfma_f32_32x32x16_bf16 v[64:79], a[84:87], v[88:91], v[64:79]
  ds_read_b64_tr_b16 v[84:85], v3 offset:24576
  ds_read_b64_tr_b16 v[86:87], v3 offset:25088
  v_add_f32 v27, 0x3727c5ac, v27
  v_cvt_pk_bf16_f32 v27, v27, v27
  v_and_b32 v27, s69, v27
  s_waitcnt lgkmcnt(4)
  v_mfma_f32_32x32x16_bf16 v[64:79], a[88:91], v[92:95], v[64:79]
  ds_read_b64_tr_b16 v[88:89], v3 offset:25600
  ds_read_b64_tr_b16 v[90:91], v3 offset:26112
  buffer_load_dwordx4 v[180:183], v2, s[48:51], s46 offen offset:1024 sc1
  v_sqrt_f32 v27, v27
s_nop 0
  v_cvt_pk_bf16_f32 v27, v27, v27
  v_and_b32 v29, s69, v27
  s_waitcnt lgkmcnt(4)
  v_mfma_f32_32x32x16_bf16 v[64:79], a[92:95], v[40:43], v[64:79]
  ds_read_b64_tr_b16 v[92:93], v3 offset:26624
  ds_read_b64_tr_b16 v[94:95], v3 offset:27136
  v_mul_f32 v29, v29, v26
  v_rcp_f32 v27, v29
s_nop 0
  v_mul_f32 v30, 0xc0135761, v27
  s_waitcnt lgkmcnt(4)
  v_mfma_f32_32x32x16_bf16 v[64:79], a[96:99], v[84:87], v[64:79]
  ds_read_b64_tr_b16 v[40:41], v3 offset:27648
  ds_read_b64_tr_b16 v[42:43], v3 offset:28160
  buffer_load_dwordx4 v[184:187], v2, s[48:51], s46 offen offset:2048 sc1
  v_mul_f32 v27, v27, v27
  v_mul_f32 v27, 0x3d372713, v27
  v_mul_f32 v31, v27, v30
  s_waitcnt lgkmcnt(4)
  v_mfma_f32_32x32x16_bf16 v[64:79], a[100:103], v[88:91], v[64:79]
  ds_read_b64_tr_b16 v[84:85], v3 offset:28672
  ds_read_b64_tr_b16 v[86:87], v3 offset:29184
  s_add_u32 s10, s98, 5242880
  buffer_store_dwordx4 v[12:15], v2, s[48:51], s10 offen sc1
  buffer_store_dwordx4 v[16:19], v2, s[48:51], s10 offen offset:1024 sc1
  s_waitcnt lgkmcnt(4)
  v_mfma_f32_32x32x16_bf16 v[64:79], a[104:107], v[92:95], v[64:79]
  ds_read_b64_tr_b16 v[88:89], v3 offset:29696
  ds_read_b64_tr_b16 v[90:91], v3 offset:30208
  buffer_load_dwordx4 v[188:191], v2, s[48:51], s46 offen offset:3072 sc1
  s_waitcnt lgkmcnt(4)
  v_mfma_f32_32x32x16_bf16 v[64:79], a[108:111], v[40:43], v[64:79]
  ds_read_b64_tr_b16 v[92:93], v3 offset:30720
  ds_read_b64_tr_b16 v[94:95], v3 offset:31232
  s_waitcnt lgkmcnt(4)
  v_mfma_f32_32x32x16_bf16 v[64:79], a[112:115], v[84:87], v[64:79]
  ds_read_b64_tr_b16 v[40:41], v3 offset:31744
  ds_read_b64_tr_b16 v[42:43], v3 offset:32256
  s_waitcnt lgkmcnt(4)
  v_mfma_f32_32x32x16_bf16 v[64:79], a[116:119], v[88:91], v[64:79]
  s_waitcnt lgkmcnt(2)
  v_mfma_f32_32x32x16_bf16 v[64:79], a[120:123], v[92:95], v[64:79]
  s_waitcnt lgkmcnt(0)
  v_mfma_f32_32x32x16_bf16 v[64:79], a[124:127], v[40:43], v[64:79]
  v_mfma_f32_32x32x16_bf16 v[64:79], v[8:11], v[44:47], v[64:79]
  v_lshlrev_b32 v40, 16, v12
  v_and_b32 v41, s69, v12
  v_sub_f32 v40, v40, v20
  v_sub_f32 v41, v41, v20
  v_cvt_pk_bf16_f32 v40, v40, v41
  v_and_b32 v41, s69, v40
  v_lshlrev_b32 v40, 16, v40
  v_mul_f32 v40, v40, v21
  v_mul_f32 v41, v41, v21
  v_cvt_pk_bf16_f32 v40, v40, v41
  v_lshlrev_b32 v96, 16, v40
  v_and_b32 v97, s69, v40
  v_pk_mul_f32 v[32:33], v[64:65], v[64:65]
  v_pk_mul_f32 v[34:35], v[66:67], v[66:67]
  v_pk_fma_f32 v[32:33], v[32:33], v[30:31], v[30:31] op_sel:[0,1,0] op_sel_hi:[1,1,0]
  v_pk_fma_f32 v[34:35], v[34:35], v[30:31], v[30:31] op_sel:[0,1,0] op_sel_hi:[1,1,0]
  v_pk_mul_f32 v[32:33], v[32:33], v[64:65]
  v_pk_mul_f32 v[34:35], v[34:35], v[66:67]
  v_exp_f32 v32, v32
  v_exp_f32 v33, v33
  v_exp_f32 v34, v34
  v_exp_f32 v35, v35
  v_pk_fma_f32 v[32:33], v[32:33], v[28:29], v[28:29] op_sel:[0,1,1] op_sel_hi:[1,1,1]
  v_pk_fma_f32 v[34:35], v[34:35], v[28:29], v[28:29] op_sel:[0,1,1] op_sel_hi:[1,1,1]
  v_rcp_f32 v32, v32
  v_rcp_f32 v33, v33
  v_rcp_f32 v34, v34
  v_rcp_f32 v35, v35
  v_pk_mul_f32 v[32:33], v[32:33], v[64:65]
  v_pk_mul_f32 v[34:35], v[34:35], v[66:67]
  v_cvt_pk_bf16_f32 v80, v32, v33
  v_cvt_pk_bf16_f32 v81, v34, v35
  v_pk_mul_f32 v[32:33], v[68:69], v[68:69]
  v_pk_mul_f32 v[34:35], v[70:71], v[70:71]
  v_pk_fma_f32 v[32:33], v[32:33], v[30:31], v[30:31] op_sel:[0,1,0] op_sel_hi:[1,1,0]
  v_pk_fma_f32 v[34:35], v[34:35], v[30:31], v[30:31] op_sel:[0,1,0] op_sel_hi:[1,1,0]
  v_pk_mul_f32 v[32:33], v[32:33], v[68:69]
  v_pk_mul_f32 v[34:35], v[34:35], v[70:71]
  v_exp_f32 v32, v32
  v_exp_f32 v33, v33
  v_exp_f32 v34, v34
  v_exp_f32 v35, v35
  v_pk_fma_f32 v[32:33], v[32:33], v[28:29], v[28:29] op_sel:[0,1,1] op_sel_hi:[1,1,1]
  v_pk_fma_f32 v[34:35], v[34:35], v[28:29], v[28:29] op_sel:[0,1,1] op_sel_hi:[1,1,1]
  v_rcp_f32 v32, v32
  v_rcp_f32 v33, v33
  v_rcp_f32 v34, v34
  v_rcp_f32 v35, v35
  v_pk_mul_f32 v[32:33], v[32:33], v[68:69]
  v_pk_mul_f32 v[34:35], v[34:35], v[70:71]
  v_cvt_pk_bf16_f32 v82, v32, v33
  v_cvt_pk_bf16_f32 v83, v34, v35
  buffer_store_dwordx4 v[80:83], v23, s[48:51], s96 offen sc1
  v_pk_mul_f32 v[32:33], v[72:73], v[72:73]
  v_pk_mul_f32 v[34:35], v[74:75], v[74:75]
  v_pk_fma_f32 v[32:33], v[32:33], v[30:31], v[30:31] op_sel:[0,1,0] op_sel_hi:[1,1,0]
  v_pk_fma_f32 v[34:35], v[34:35], v[30:31], v[30:31] op_sel:[0,1,0] op_sel_hi:[1,1,0]
  v_pk_mul_f32 v[32:33], v[32:33], v[72:73]
  v_pk_mul_f32 v[34:35], v[34:35], v[74:75]
  v_exp_f32 v32, v32
  v_exp_f32 v33, v33
  v_exp_f32 v34, v34
  v_exp_f32 v35, v35
  v_pk_fma_f32 v[32:33], v[32:33], v[28:29], v[28:29] op_sel:[0,1,1] op_sel_hi:[1,1,1]
  v_pk_fma_f32 v[34:35], v[34:35], v[28:29], v[28:29] op_sel:[0,1,1] op_sel_hi:[1,1,1]
  v_rcp_f32 v32, v32
  v_rcp_f32 v33, v33
  v_rcp_f32 v34, v34
  v_rcp_f32 v35, v35
  v_pk_mul_f32 v[32:33], v[32:33], v[72:73]
  v_pk_mul_f32 v[34:35], v[34:35], v[74:75]
  v_cvt_pk_bf16_f32 v84, v32, v33
  v_cvt_pk_bf16_f32 v85, v34, v35
  v_pk_mul_f32 v[32:33], v[76:77], v[76:77]
  v_pk_mul_f32 v[34:35], v[78:79], v[78:79]
  v_pk_fma_f32 v[32:33], v[32:33], v[30:31], v[30:31] op_sel:[0,1,0] op_sel_hi:[1,1,0]
  v_pk_fma_f32 v[34:35], v[34:35], v[30:31], v[30:31] op_sel:[0,1,0] op_sel_hi:[1,1,0]
  v_pk_mul_f32 v[32:33], v[32:33], v[76:77]
  v_pk_mul_f32 v[34:35], v[34:35], v[78:79]
  v_exp_f32 v32, v32
  v_exp_f32 v33, v33
  v_exp_f32 v34, v34
  v_exp_f32 v35, v35
  v_pk_fma_f32 v[32:33], v[32:33], v[28:29], v[28:29] op_sel:[0,1,1] op_sel_hi:[1,1,1]
  v_pk_fma_f32 v[34:35], v[34:35], v[28:29], v[28:29] op_sel:[0,1,1] op_sel_hi:[1,1,1]
  v_rcp_f32 v32, v32
  v_rcp_f32 v33, v33
  v_rcp_f32 v34, v34
  v_rcp_f32 v35, v35
  v_pk_mul_f32 v[32:33], v[32:33], v[76:77]
  v_pk_mul_f32 v[34:35], v[34:35], v[78:79]
  v_cvt_pk_bf16_f32 v86, v32, v33
  v_cvt_pk_bf16_f32 v87, v34, v35
  buffer_store_dwordx4 v[84:87], v23, s[48:51], s97 offen sc1
  v_lshlrev_b32 v40, 16, v13
  v_and_b32 v41, s69, v13
  v_sub_f32 v40, v40, v20
  v_sub_f32 v41, v41, v20
  v_cvt_pk_bf16_f32 v40, v40, v41
  v_and_b32 v41, s69, v40
  v_lshlrev_b32 v40, 16, v40
  v_mul_f32 v40, v40, v21
  v_mul_f32 v41, v41, v21
  v_cvt_pk_bf16_f32 v40, v40, v41
  v_lshlrev_b32 v98, 16, v40
  v_and_b32 v99, s69, v40
  v_lshlrev_b32 v40, 16, v14
  v_and_b32 v41, s69, v14
  s_add_u32 s46, s32, 16384
  s_and_b32 s46, s46, 0x7fff
  s_add_u32 s46, s46, s90
  buffer_load_dwordx4 v[192:195], v2, s[48:51], s46 offen offset:0 sc1
  v_sub_f32 v40, v40, v20
  v_sub_f32 v41, v41, v20
  v_cvt_pk_bf16_f32 v40, v40, v41
  v_and_b32 v41, s69, v40
  v_lshlrev_b32 v40, 16, v40
  v_mul_f32 v40, v40, v21
  v_mul_f32 v41, v41, v21
  v_cvt_pk_bf16_f32 v40, v40, v41
  v_lshlrev_b32 v100, 16, v40
  v_and_b32 v101, s69, v40
  v_lshlrev_b32 v40, 16, v15
  v_and_b32 v41, s69, v15
  v_sub_f32 v40, v40, v20
  v_sub_f32 v41, v41, v20
  buffer_load_dwordx4 v[196:199], v2, s[48:51], s46 offen offset:1024 sc1
  v_cvt_pk_bf16_f32 v40, v40, v41
  v_and_b32 v41, s69, v40
  v_lshlrev_b32 v40, 16, v40
  v_mul_f32 v40, v40, v21
  v_mul_f32 v41, v41, v21
  v_cvt_pk_bf16_f32 v40, v40, v41
  v_lshlrev_b32 v102, 16, v40
  v_and_b32 v103, s69, v40
  v_lshlrev_b32 v40, 16, v16
  v_and_b32 v41, s69, v16
  v_sub_f32 v40, v40, v20
  v_sub_f32 v41, v41, v20
  v_cvt_pk_bf16_f32 v40, v40, v41
  v_and_b32 v41, s69, v40
  buffer_load_dwordx4 v[200:203], v2, s[48:51], s46 offen offset:2048 sc1
  v_lshlrev_b32 v40, 16, v40
  v_mul_f32 v40, v40, v21
  v_mul_f32 v41, v41, v21
  v_cvt_pk_bf16_f32 v40, v40, v41
  v_lshlrev_b32 v104, 16, v40
  v_and_b32 v105, s69, v40
  v_lshlrev_b32 v40, 16, v17
  v_and_b32 v41, s69, v17
  v_sub_f32 v40, v40, v20
  v_sub_f32 v41, v41, v20
  v_cvt_pk_bf16_f32 v40, v40, v41
  v_and_b32 v41, s69, v40
  v_lshlrev_b32 v40, 16, v40
  v_mul_f32 v40, v40, v21
  buffer_load_dwordx4 v[204:207], v2, s[48:51], s46 offen offset:3072 sc1
  v_mul_f32 v41, v41, v21
  v_cvt_pk_bf16_f32 v40, v40, v41
  v_lshlrev_b32 v106, 16, v40
  v_and_b32 v107, s69, v40
  v_lshlrev_b32 v40, 16, v18
  v_and_b32 v41, s69, v18
  v_sub_f32 v40, v40, v20
  v_sub_f32 v41, v41, v20
  v_cvt_pk_bf16_f32 v40, v40, v41
  v_and_b32 v41, s69, v40
  v_lshlrev_b32 v40, 16, v40
  v_mul_f32 v40, v40, v21
  v_mul_f32 v41, v41, v21
  v_cvt_pk_bf16_f32 v40, v40, v41
  s_add_u32 s46, s32, 20480
  s_and_b32 s46, s46, 0x7fff
  s_add_u32 s46, s46, s90
  buffer_load_dwordx4 v[208:211], v2, s[48:51], s46 offen offset:0 sc1
  v_lshlrev_b32 v108, 16, v40
  v_and_b32 v109, s69, v40
  v_lshlrev_b32 v40, 16, v19
  v_and_b32 v41, s69, v19
  v_sub_f32 v40, v40, v20
  v_sub_f32 v41, v41, v20
  v_cvt_pk_bf16_f32 v40, v40, v41
  v_and_b32 v41, s69, v40
  v_lshlrev_b32 v40, 16, v40
  v_mul_f32 v40, v40, v21
  v_mul_f32 v41, v41, v21
  v_cvt_pk_bf16_f32 v40, v40, v41
  v_lshlrev_b32 v110, 16, v40
  v_and_b32 v111, s69, v40
  buffer_load_dwordx4 v[212:215], v2, s[48:51], s46 offen offset:1024 sc1
  v_mov_b32 v44, 1
  s_waitcnt vmcnt(6)
  s_barrier
  s_cmp_lg_u32 s3, 0
  s_cbranch_scc1 Q3
  s_mov_b64 exec, 1
  buffer_store_dword v44, off, s[48:51], s99 sc1
  s_mov_b64 exec, -1
Q3:
  buffer_load_dwordx4 v[80:83], v23, s[48:51], s96 offen sc1
  buffer_load_dwordx4 v[84:87], v23, s[48:51], s97 offen sc1
  s_and_b32 s8, s3, 1
  s_lshl_b32 s8, s8, 1
  s_sub_u32 s8, s8, 1
  s_lshr_b32 s9, s3, 1
  s_lshl_b32 s8, s8, s9
  s_lshl_b32 s9, s71, 5
  s_add_u32 s8, s8, s9
  v_and_b32 v4, 31, v1
  v_add_u32 v4, s8, v4
  v_cmp_gt_u32 vcc, 2048, v4
  v_lshlrev_b32 v4, 4, v4
  v_lshrrev_b32 v5, 5, v1
  v_lshl_add_u32 v4, v5, 15, v4
  v_mov_b32 v5, 0x80000000
  v_cndmask_b32 v4, v5, v4, vcc
  v_add_u32 v24, 40960, v2
  v_and_b32 v26, 31, v1
  v_lshlrev_b32 v26, 5, v26
  s_lshl_b32 s12, s71, 10
  s_lshl_b32 s9, s72, 3
  s_add_u32 s12, s12, s9
  s_add_u32 s12, s12, 65536
  s_lshl_b32 s9, s3, 13
  s_lshl_b32 s8, s3, 19
  s_add_u32 s8, s8, 3145728
  v_mov_b32 v25, v6
  buffer_load_dwordx4 v[216:219], v2, s[48:51], s46 offen offset:2048 sc1
  buffer_load_dwordx4 v[220:223], v2, s[48:51], s46 offen offset:3072 sc1
  s_cmp_lg_u32 s3, 0
  s_cbranch_scc1 P4_done
  v_and_b32 v40, 3, v1
  v_and_b32 v41, 1, v1
  v_lshlrev_b32 v41, 1, v41
  v_subrev_u32 v41, 1, v41
  v_bfe_u32 v42, v1, 2, 1
  v_mul_i32_i24 v41, v41, v42
  v_add_u32 v41, s71, v41
  v_max_i32 v41, 0, v41
  v_min_i32 v41, 63, v41
  v_and_b32 v6, 7, v41
  v_lshl_add_u32 v6, v6, 2, v40
  v_lshrrev_b32 v41, 3, v41
  v_lshl_add_u32 v6, v6, 3, v41
  v_lshlrev_b32 v6, 7, v6
  s_mov_b32 s6, 30000
P4_loop:
  buffer_load_dword v5, v6, s[48:51], 0 offen sc1
  s_sub_u32 s6, s6, 1
  s_cbranch_scc1 P4_done
  s_waitcnt vmcnt(0)
  v_cmp_gt_u32 vcc, 1, v5
s_nop 4
  s_cbranch_vccnz P4_loop
P4_done:
  s_barrier
  s_add_u32 m0, s9, 40960
  s_add_u32 s10, s8, 0
  buffer_load_dwordx4 v4, s[48:51], s10 offen sc1 lds
  s_add_u32 m0, s9, 41984
  s_add_u32 s10, s8, 65536
  buffer_load_dwordx4 v4, s[48:51], s10 offen sc1 lds
  s_add_u32 m0, s9, 43008
  s_add_u32 s10, s8, 131072
  buffer_load_dwordx4 v4, s[48:51], s10 offen sc1 lds
  s_add_u32 m0, s9, 44032
  s_add_u32 s10, s8, 196608
  buffer_load_dwordx4 v4, s[48:51], s10 offen sc1 lds
  s_add_u32 m0, s9, 45056
  s_add_u32 s10, s8, 262144
  buffer_load_dwordx4 v4, s[48:51], s10 offen sc1 lds
  s_add_u32 m0, s9, 46080
  s_add_u32 s10, s8, 327680
  buffer_load_dwordx4 v4, s[48:51], s10 offen sc1 lds
  s_add_u32 m0, s9, 47104
  s_add_u32 s10, s8, 393216
  buffer_load_dwordx4 v4, s[48:51], s10 offen sc1 lds
  s_add_u32 m0, s9, 48128
  s_add_u32 s10, s8, 458752
  buffer_load_dwordx4 v4, s[48:51], s10 offen sc1 lds
  s_add_u32 s46, s32, 24576
  s_and_b32 s46, s46, 0x7fff
  s_add_u32 s46, s46, s90
  buffer_load_dwordx4 v[224:227], v2, s[48:51], s46 offen offset:0 sc1
  buffer_load_dwordx4 v[228:231], v2, s[48:51], s46 offen offset:1024 sc1
  buffer_load_dwordx4 v[232:235], v2, s[48:51], s46 offen offset:2048 sc1
  buffer_load_dwordx4 v[236:239], v2, s[48:51], s46 offen offset:3072 sc1
  s_waitcnt vmcnt(4)
  s_barrier
  ds_read_b128 v[80:83], v24 offset:0
  ds_read_b128 v[84:87], v24 offset:1024
  ds_read_b128 v[88:91], v24 offset:2048
  s_waitcnt lgkmcnt(2)
  v_mfma_f32_32x32x16_bf16 v[64:79], a[128:131], v[80:83], 0
  ds_read_b128 v[92:95], v24 offset:3072
  s_add_u32 s46, s32, 28672
  s_and_b32 s46, s46, 0x7fff
  s_add_u32 s46, s46, s90
  buffer_load_dwordx4 v[240:243], v2, s[48:51], s46 offen offset:0 sc1
  s_waitcnt lgkmcnt(2)
  v_mfma_f32_32x32x16_bf16 v[64:79], a[132:135], v[84:87], v[64:79]
  ds_read_b128 v[80:83], v24 offset:4096
  s_waitcnt lgkmcnt(2)
  v_mfma_f32_32x32x16_bf16 v[64:79], a[136:139], v[88:91], v[64:79]
  ds_read_b128 v[84:87], v24 offset:5120
  buffer_load_dwordx4 v[244:247], v2, s[48:51], s46 offen offset:1024 sc1
  s_waitcnt lgkmcnt(2)
  v_mfma_f32_32x32x16_bf16 v[64:79], a[140:143], v[92:95], v[64:79]
  ds_read_b128 v[88:91], v24 offset:6144
  s_waitcnt lgkmcnt(2)
  v_mfma_f32_32x32x16_bf16 v[64:79], a[144:147], v[80:83], v[64:79]
  ds_read_b128 v[92:95], v24 offset:7168
  buffer_load_dwordx4 v[248:251], v2, s[48:51], s46 offen offset:2048 sc1
  s_waitcnt lgkmcnt(2)
  v_mfma_f32_32x32x16_bf16 v[64:79], a[148:151], v[84:87], v[64:79]
  ds_read_b128 v[80:83], v24 offset:8192
  s_waitcnt lgkmcnt(2)
  v_mfma_f32_32x32x16_bf16 v[64:79], a[152:155], v[88:91], v[64:79]
  ds_read_b128 v[84:87], v24 offset:9216
  buffer_load_dwordx4 v[252:255], v2, s[48:51], s46 offen offset:3072 sc1
  s_waitcnt lgkmcnt(2)
  v_mfma_f32_32x32x16_bf16 v[64:79], a[156:159], v[92:95], v[64:79]
  ds_read_b128 v[88:91], v24 offset:10240
  s_waitcnt lgkmcnt(2)
  v_mfma_f32_32x32x16_bf16 v[64:79], a[160:163], v[80:83], v[64:79]
  ds_read_b128 v[92:95], v24 offset:11264
  s_add_u32 s46, s91, 0
  buffer_load_dwordx4 a[0:3], v2, s[48:51], s46 offen offset:0 sc1
  s_waitcnt lgkmcnt(2)
  v_mfma_f32_32x32x16_bf16 v[64:79], a[164:167], v[84:87], v[64:79]
  ds_read_b128 v[80:83], v24 offset:12288
  s_waitcnt lgkmcnt(2)
  v_mfma_f32_32x32x16_bf16 v[64:79], a[168:171], v[88:91], v[64:79]
  ds_read_b128 v[84:87], v24 offset:13312
  s_add_u32 s47, s92, 0
  buffer_load_dwordx4 a[4:7], v2, s[48:51], s47 offen offset:0 sc1
  s_waitcnt lgkmcnt(2)
  v_mfma_f32_32x32x16_bf16 v[64:79], a[172:175], v[92:95], v[64:79]
  ds_read_b128 v[88:91], v24 offset:14336
  s_waitcnt lgkmcnt(2)
  v_mfma_f32_32x32x16_bf16 v[64:79], a[176:179], v[80:83], v[64:79]
  ds_read_b128 v[92:95], v24 offset:15360
  buffer_load_dwordx4 a[8:11], v2, s[48:51], s46 offen offset:1024 sc1
  s_waitcnt lgkmcnt(2)
  v_mfma_f32_32x32x16_bf16 v[64:79], a[180:183], v[84:87], v[64:79]
  ds_read_b128 v[80:83], v24 offset:16384
  s_waitcnt lgkmcnt(2)
  v_mfma_f32_32x32x16_bf16 v[64:79], a[184:187], v[88:91], v[64:79]
  ds_read_b128 v[84:87], v24 offset:17408
  buffer_load_dwordx4 a[12:15], v2, s[48:51], s47 offen offset:1024 sc1
  s_waitcnt lgkmcnt(2)
  v_mfma_f32_32x32x16_bf16 v[64:79], a[188:191], v[92:95], v[64:79]
  ds_read_b128 v[88:91], v24 offset:18432
  s_waitcnt lgkmcnt(2)
  v_mfma_f32_32x32x16_bf16 v[64:79], a[192:195], v[80:83], v[64:79]
  ds_read_b128 v[92:95], v24 offset:19456
  buffer_load_dwordx4 a[16:19], v2, s[48:51], s46 offen offset:2048 sc1
  s_waitcnt lgkmcnt(2)
  v_mfma_f32_32x32x16_bf16 v[64:79], a[196:199], v[84:87], v[64:79]
  ds_read_b128 v[80:83], v24 offset:20480
  s_waitcnt lgkmcnt(2)
  v_mfma_f32_32x32x16_bf16 v[64:79], a[200:203], v[88:91], v[64:79]
  ds_read_b128 v[84:87], v24 offset:21504
  buffer_load_dwordx4 a[20:23], v2, s[48:51], s47 offen offset:2048 sc1
  s_waitcnt lgkmcnt(2)
  v_mfma_f32_32x32x16_bf16 v[64:79], a[204:207], v[92:95], v[64:79]
  ds_read_b128 v[88:91], v24 offset:22528
  s_waitcnt lgkmcnt(2)
  v_mfma_f32_32x32x16_bf16 v[64:79], a[208:211], v[80:83], v[64:79]
  ds_read_b128 v[92:95], v24 offset:23552
  buffer_load_dwordx4 a[24:27], v2, s[48:51], s46 offen offset:3072 sc1
  s_waitcnt lgkmcnt(2)
  v_mfma_f32_32x32x16_bf16 v[64:79], a[212:215], v[84:87], v[64:79]
  ds_read_b128 v[80:83], v24 offset:24576
  s_waitcnt lgkmcnt(2)
  v_mfma_f32_32x32x16_bf16 v[64:79], a[216:219], v[88:91], v[64:79]
  ds_read_b128 v[84:87], v24 offset:25600
  buffer_load_dwordx4 a[28:31], v2, s[48:51], s47 offen offset:3072 sc1
  s_waitcnt lgkmcnt(2)
  v_mfma_f32_32x32x16_bf16 v[64:79], a[220:223], v[92:95], v[64:79]
  ds_read_b128 v[88:91], v24 offset:26624
  s_waitcnt lgkmcnt(2)
  v_mfma_f32_32x32x16_bf16 v[64:79], a[224:227], v[80:83], v[64:79]
  ds_read_b128 v[92:95], v24 offset:27648
  s_add_u32 s46, s91, 4096
  buffer_load_dwordx4 a[32:35], v2, s[48:51], s46 offen offset:0 sc1
  s_waitcnt lgkmcnt(2)
  v_mfma_f32_32x32x16_bf16 v[64:79], a[228:231], v[84:87], v[64:79]
  ds_read_b128 v[80:83], v24 offset:28672
  s_waitcnt lgkmcnt(2)
  v_mfma_f32_32x32x16_bf16 v[64:79], a[232:235], v[88:91], v[64:79]
  ds_read_b128 v[84:87], v24 offset:29696
  s_add_u32 s47, s92, 4096
  buffer_load_dwordx4 a[36:39], v2, s[48:51], s47 offen offset:0 sc1
  s_waitcnt lgkmcnt(2)
  v_mfma_f32_32x32x16_bf16 v[64:79], a[236:239], v[92:95], v[64:79]
  ds_read_b128 v[88:91], v24 offset:30720
  s_waitcnt lgkmcnt(2)
  v_mfma_f32_32x32x16_bf16 v[64:79], a[240:243], v[80:83], v[64:79]
  ds_read_b128 v[92:95], v24 offset:31744
  s_waitcnt lgkmcnt(2)
  v_mfma_f32_32x32x16_bf16 v[64:79], a[244:247], v[84:87], v[64:79]
  s_waitcnt lgkmcnt(1)
  v_mfma_f32_32x32x16_bf16 v[64:79], a[248:251], v[88:91], v[64:79]
  s_waitcnt lgkmcnt(0)
  v_mfma_f32_32x32x16_bf16 v[64:79], a[252:255], v[92:95], v[64:79]
s_nop 11
  v_cvt_pk_bf16_f32 v80, v64, v65
  v_cvt_pk_bf16_f32 v81, v66, v67
  v_cvt_pk_bf16_f32 v82, v68, v69
  v_cvt_pk_bf16_f32 v83, v70, v71
  v_cvt_pk_bf16_f32 v84, v72, v73
  v_cvt_pk_bf16_f32 v85, v74, v75
  v_cvt_pk_bf16_f32 v86, v76, v77
  v_cvt_pk_bf16_f32 v87, v78, v79
  v_lshlrev_b32 v64, 16, v80
  v_and_b32 v65, s69, v80
  v_lshlrev_b32 v66, 16, v81
  v_and_b32 v67, s69, v81
  v_lshlrev_b32 v68, 16, v82
  v_and_b32 v69, s69, v82
  v_lshlrev_b32 v70, 16, v83
  v_and_b32 v71, s69, v83
  v_lshlrev_b32 v72, 16, v84
  v_and_b32 v73, s69, v84
  v_lshlrev_b32 v74, 16, v85
  v_and_b32 v75, s69, v85
  v_lshlrev_b32 v76, 16, v86
  v_and_b32 v77, s69, v86
  v_lshlrev_b32 v78, 16, v87
  v_and_b32 v79, s69, v87
  v_pk_add_f32 v[64:65], v[64:65], v[96:97]
  v_pk_add_f32 v[66:67], v[66:67], v[98:99]
  v_pk_add_f32 v[68:69], v[68:69], v[100:101]
  v_pk_add_f32 v[70:71], v[70:71], v[102:103]
  v_pk_add_f32 v[72:73], v[72:73], v[104:105]
  v_pk_add_f32 v[74:75], v[74:75], v[106:107]
  v_pk_add_f32 v[76:77], v[76:77], v[108:109]
  v_pk_add_f32 v[78:79], v[78:79], v[110:111]
  v_cvt_pk_bf16_f32 v80, v64, v65
  v_cvt_pk_bf16_f32 v81, v66, v67
  v_cvt_pk_bf16_f32 v82, v68, v69
  v_cvt_pk_bf16_f32 v83, v70, v71
  v_cvt_pk_bf16_f32 v84, v72, v73
  v_cvt_pk_bf16_f32 v85, v74, v75
  v_cvt_pk_bf16_f32 v86, v76, v77
  v_cvt_pk_bf16_f32 v87, v78, v79
  s_add_u32 s13, s98, 7340032
  buffer_store_dwordx4 v[80:83], v2, s[48:51], s13 offen sc1
  buffer_store_dwordx4 v[84:87], v2, s[48:51], s13 offen offset:1024 sc1
  v_dot2_f32_bf16 v40, v80, s68, 0
  v_dot2_f32_bf16 v41, v80, v80, 0
  v_dot2_f32_bf16 v40, v81, s68, v40
  v_dot2_f32_bf16 v41, v81, v81, v41
  v_dot2_f32_bf16 v40, v82, s68, v40
  v_dot2_f32_bf16 v41, v82, v82, v41
  v_dot2_f32_bf16 v40, v83, s68, v40
  v_dot2_f32_bf16 v41, v83, v83, v41
  v_dot2_f32_bf16 v40, v84, s68, v40
  v_dot2_f32_bf16 v41, v84, v84, v41
  v_dot2_f32_bf16 v40, v85, s68, v40
  v_dot2_f32_bf16 v41, v85, v85, v41
  v_dot2_f32_bf16 v40, v86, s68, v40
  v_dot2_f32_bf16 v41, v86, v86, v41
  v_dot2_f32_bf16 v40, v87, s68, v40
  v_dot2_f32_bf16 v41, v87, v87, v41
s_nop 2
  ds_write_b64 v25, v[40:41]
  s_waitcnt lgkmcnt(0)
  s_barrier
  ds_read_b64 v[96:97], v22 offset:0
  ds_read_b64 v[98:99], v22 offset:256
  ds_read_b64 v[100:101], v22 offset:512
  ds_read_b64 v[102:103], v22 offset:768
  ds_read_b64 v[104:105], v22 offset:1024
  ds_read_b64 v[106:107], v22 offset:1280
  ds_read_b64 v[108:109], v22 offset:1536
  ds_read_b64 v[110:111], v22 offset:1792
  s_lshl_b32 s9, s3, 3
  s_mov_b32 s8, 0xff
  s_lshl_b32 s8, s8, s9
  s_waitcnt lgkmcnt(0)
  s_waitcnt vmcnt(12)
  v_pk_add_f32 v[96:97], v[96:97], v[104:105]
  v_pk_add_f32 v[98:99], v[98:99], v[106:107]
  v_pk_add_f32 v[100:101], v[100:101], v[108:109]
  v_pk_add_f32 v[102:103], v[102:103], v[110:111]
  v_pk_add_f32 v[96:97], v[96:97], v[100:101]
  v_pk_add_f32 v[98:99], v[98:99], v[102:103]
  v_pk_add_f32 v[96:97], v[96:97], v[98:99]
  s_mov_b32 exec_lo, s8
  s_mov_b32 exec_hi, 0
  buffer_store_dwordx2 v[96:97], v26, s[48:51], s12 offen sc1
  s_mov_b64 exec, -1
  v_mov_b32 v44, 2
  v_mov_b32 v80, s68
  v_mov_b32 v81, s68
  v_mov_b32 v82, s68
  v_mov_b32 v83, s68
s_nop 1
  v_mfma_f32_32x32x16_bf16 v[64:79], v[80:83], v[128:131], 0
  v_mfma_f32_32x32x16_bf16 v[64:79], v[80:83], v[132:135], v[64:79]
  v_mfma_f32_32x32x16_bf16 v[64:79], v[80:83], v[136:139], v[64:79]
  v_mfma_f32_32x32x16_bf16 v[64:79], v[80:83], v[140:143], v[64:79]
  v_mfma_f32_32x32x16_bf16 v[64:79], v[80:83], v[144:147], v[64:79]
  v_mfma_f32_32x32x16_bf16 v[64:79], v[80:83], v[148:151], v[64:79]
  v_mfma_f32_32x32x16_bf16 v[64:79], v[80:83], v[152:155], v[64:79]
  v_mfma_f32_32x32x16_bf16 v[64:79], v[80:83], v[156:159], v[64:79]
  v_mfma_f32_32x32x16_bf16 v[64:79], v[80:83], v[160:163], v[64:79]
  v_mfma_f32_32x32x16_bf16 v[64:79], v[80:83], v[164:167], v[64:79]
  v_mfma_f32_32x32x16_bf16 v[64:79], v[80:83], v[168:171], v[64:79]
  s_waitcnt vmcnt(0)
  s_barrier
  s_cmp_lg_u32 s3, 0
  s_cbranch_scc1 Q5
  s_mov_b64 exec, 1
  buffer_store_dword v44, off, s[48:51], s99 sc1
  s_mov_b64 exec, -1
Q5:
  buffer_load_dwordx4 v[28:31], v2, s[48:51], s13 offen sc1
  buffer_load_dwordx4 v[28:31], v2, s[48:51], s13 offen offset:1024 sc1
  v_mfma_f32_32x32x16_bf16 v[64:79], v[80:83], v[172:175], v[64:79]
  buffer_load_dwordx4 a[40:43], v2, s[48:51], s46 offen offset:1024 sc1
  v_mfma_f32_32x32x16_bf16 v[64:79], v[80:83], v[176:179], v[64:79]
  v_mfma_f32_32x32x16_bf16 v[64:79], v[80:83], v[180:183], v[64:79]
  buffer_load_dwordx4 a[44:47], v2, s[48:51], s47 offen offset:1024 sc1
  v_mfma_f32_32x32x16_bf16 v[64:79], v[80:83], v[184:187], v[64:79]
  v_mfma_f32_32x32x16_bf16 v[64:79], v[80:83], v[188:191], v[64:79]
  buffer_load_dwordx4 a[48:51], v2, s[48:51], s46 offen offset:2048 sc1
  v_mfma_f32_32x32x16_bf16 v[64:79], v[80:83], v[192:195], v[64:79]
  v_mfma_f32_32x32x16_bf16 v[64:79], v[80:83], v[196:199], v[64:79]
  buffer_load_dwordx4 a[52:55], v2, s[48:51], s47 offen offset:2048 sc1
  v_mfma_f32_32x32x16_bf16 v[64:79], v[80:83], v[200:203], v[64:79]
  v_mfma_f32_32x32x16_bf16 v[64:79], v[80:83], v[204:207], v[64:79]
  buffer_load_dwordx4 a[56:59], v2, s[48:51], s46 offen offset:3072 sc1
  v_mfma_f32_32x32x16_bf16 v[64:79], v[80:83], v[208:211], v[64:79]
  v_mfma_f32_32x32x16_bf16 v[64:79], v[80:83], v[212:215], v[64:79]
  buffer_load_dwordx4 a[60:63], v2, s[48:51], s47 offen offset:3072 sc1
  v_mfma_f32_32x32x16_bf16 v[64:79], v[80:83], v[216:219], v[64:79]
  v_mfma_f32_32x32x16_bf16 v[64:79], v[80:83], v[220:223], v[64:79]
  s_add_u32 s46, s91, 8192
  buffer_load_dwordx4 a[64:67], v2, s[48:51], s46 offen offset:0 sc1
  v_mfma_f32_32x32x16_bf16 v[64:79], v[80:83], v[224:227], v[64:79]
  v_mfma_f32_32x32x16_bf16 v[64:79], v[80:83], v[228:231], v[64:79]
  s_add_u32 s47, s92, 8192
  buffer_load_dwordx4 a[68:71], v2, s[48:51], s47 offen offset:0 sc1
  v_mfma_f32_32x32x16_bf16 v[64:79], v[80:83], v[232:235], v[64:79]
  v_mfma_f32_32x32x16_bf16 v[64:79], v[80:83], v[236:239], v[64:79]
  v_mfma_f32_32x32x16_bf16 v[64:79], v[80:83], v[240:243], v[64:79]
  v_mfma_f32_32x32x16_bf16 v[64:79], v[80:83], v[244:247], v[64:79]
  v_mfma_f32_32x32x16_bf16 v[64:79], v[80:83], v[248:251], v[64:79]
  v_mfma_f32_32x32x16_bf16 v[64:79], v[80:83], v[252:255], v[64:79]
s_nop 11
  v_cvt_pk_bf16_f32 v65, v64, v64
  v_and_b32 v65, s69, v65
  v_sub_f32 v64, v64, v65
  v_cvt_pk_bf16_f32 v66, v64, v64
  v_and_b32 v66, s69, v66
  v_sub_f32 v67, v64, v66
  v_cvt_pk_bf16_f32 v8, v65, v66
  v_cvt_pk_bf16_f32 v9, v67, v65
  v_cvt_pk_bf16_f32 v10, v66, 0
  v_mov_b32 v11, 0
  v_and_b32 v4, 31, v1
  v_lshlrev_b32 v4, 5, v4
  s_lshl_b32 s8, s73, 12
  s_lshl_b32 s9, s3, 10
  s_add_u32 s8, s8, s9
  s_add_u32 s13, s8, 65536
  s_lshl_b32 s9, s3, 8
  v_add_u32 v23, s9, v22
  s_lshl_b32 s8, s73, 17
  s_lshl_b32 s9, s33, 13
  s_add_u32 s8, s8, s9
  s_lshl_b32 s9, s3, 13
  s_add_u32 s96, s8, 7340032
  s_mul_i32 s8, s73, 458752
  s_lshl_b32 s10, s74, 13
  s_lshl_b32 s11, s3, 11
  s_add_u32 s8, s8, s10
  s_add_u32 s8, s8, s11
  s_add_u32 s97, s8, 9437184
  v_mov_b32 v46, 0
  v_mov_b32 v47, 0
  s_cmp_lg_u32 s3, 0
  s_cbranch_scc1 P6_done
  s_lshl_b32 s8, s73, 2
  v_bfe_u32 v41, v1, 2, 2
  v_add_u32 v41, s8, v41
  v_and_b32 v40, 3, v1
  v_and_b32 v6, 7, v41
  v_lshl_add_u32 v6, v6, 2, v40
  v_lshrrev_b32 v41, 3, v41
  v_lshl_add_u32 v6, v6, 3, v41
  v_lshlrev_b32 v6, 7, v6
  s_mov_b32 s6, 30000
P6_loop:
  buffer_load_dword v5, v6, s[48:51], 0 offen sc1
  s_sub_u32 s6, s6, 1
  s_cbranch_scc1 P6_done
  s_waitcnt vmcnt(0)
  v_cmp_gt_u32 vcc, 2, v5
s_nop 4
  s_cbranch_vccnz P6_loop
P6_done:
  s_barrier
  s_cmp_ge_u32 s74, 14
  s_cbranch_scc1 L_g3skip
  s_add_u32 m0, s9, 0
  s_add_u32 s10, s96, 0
  buffer_load_dwordx4 v2, s[48:51], s10 offen offset:0 sc1 lds
  buffer_load_dwordx4 v2, s[48:51], s10 offen offset:1024 sc1 lds
  buffer_load_dwordx4 v2, s[48:51], s10 offen offset:2048 sc1 lds
  buffer_load_dwordx4 v2, s[48:51], s10 offen offset:3072 sc1 lds
  s_add_u32 m0, s9, 4096
  s_add_u32 s10, s96, 4096
  buffer_load_dwordx4 v2, s[48:51], s10 offen offset:0 sc1 lds
  buffer_load_dwordx4 v2, s[48:51], s10 offen offset:1024 sc1 lds
  buffer_load_dwordx4 v2, s[48:51], s10 offen offset:2048 sc1 lds
  buffer_load_dwordx4 v2, s[48:51], s10 offen offset:3072 sc1 lds
  buffer_load_dwordx4 v[24:27], v4, s[48:51], s13 offen sc1
  buffer_load_dwordx4 v[28:31], v4, s[48:51], s13 offen offset:16 sc1
  buffer_load_dwordx4 a[72:75], v2, s[48:51], s46 offen offset:1024 sc1
  buffer_load_dwordx4 a[76:79], v2, s[48:51], s47 offen offset:1024 sc1
  buffer_load_dwordx4 a[80:83], v2, s[48:51], s46 offen offset:2048 sc1
  buffer_load_dwordx4 a[84:87], v2, s[48:51], s47 offen offset:2048 sc1
  v_add_u32 v5, 65536, v2
  s_waitcnt vmcnt(6)
  s_barrier
  ds_read_b128 v[48:51], v2 offset:0
  ds_read_b128 v[52:55], v2 offset:1024
  ds_read_b128 v[56:59], v2 offset:2048
  ds_read_b128 v[60:63], v2 offset:3072
  s_waitcnt lgkmcnt(2)
  v_mfma_f32_32x32x16_bf16 v[64:79], v[128:131], v[48:51], 0
  ds_read_b128 v[96:99], v2 offset:4096
  s_add_u32 m0, s9, 32768
  s_add_u32 s8, s96, 32768
  buffer_load_dwordx4 v2, s[48:51], s8 offen offset:0 sc1 lds
  v_mfma_f32_32x32x16_bf16 v[64:79], v[132:135], v[52:55], v[64:79]
  ds_read_b128 v[100:103], v2 offset:5120
  buffer_load_dwordx4 v2, s[48:51], s8 offen offset:1024 sc1 lds
  buffer_load_dwordx4 v2, s[48:51], s8 offen offset:2048 sc1 lds
  s_waitcnt lgkmcnt(2)
  v_mfma_f32_32x32x16_bf16 v[64:79], v[136:139], v[56:59], v[64:79]
  ds_read_b128 v[104:107], v2 offset:6144
  buffer_load_dwordx4 v2, s[48:51], s8 offen offset:3072 sc1 lds
  v_mfma_f32_32x32x16_bf16 v[64:79], v[140:143], v[60:63], v[64:79]
  ds_read_b128 v[108:111], v2 offset:7168
  s_waitcnt vmcnt(8)
  v_add_f32 v24, v24, v26
  s_waitcnt lgkmcnt(2)
  v_mfma_f32_32x32x16_bf16 v[64:79], v[144:147], v[96:99], v[64:79]
  ds_read_b128 v[48:51], v2 offset:8192
  s_add_u32 m0, s9, 36864
  s_add_u32 s8, s96, 36864
  buffer_load_dwordx4 v2, s[48:51], s8 offen offset:0 sc1 lds
  v_mfma_f32_32x32x16_bf16 v[64:79], v[148:151], v[100:103], v[64:79]
  ds_read_b128 v[52:55], v2 offset:9216
  v_add_f32 v25, v25, v27
  v_add_f32 v28, v28, v30
  s_waitcnt lgkmcnt(2)
  v_mfma_f32_32x32x16_bf16 v[64:79], v[152:155], v[104:107], v[64:79]
  ds_read_b128 v[56:59], v2 offset:10240
  buffer_load_dwordx4 v2, s[48:51], s8 offen offset:1024 sc1 lds
  v_add_f32 v29, v29, v31
  v_mfma_f32_32x32x16_bf16 v[64:79], v[156:159], v[108:111], v[64:79]
  ds_read_b128 v[60:63], v2 offset:11264
  v_add_f32 v24, v24, v28
  s_waitcnt lgkmcnt(2)
  v_mfma_f32_32x32x16_bf16 v[64:79], v[160:163], v[48:51], v[64:79]
  ds_read_b128 v[96:99], v2 offset:12288
  buffer_load_dwordx4 v2, s[48:51], s8 offen offset:2048 sc1 lds
  v_add_f32 v25, v25, v29
  v_mfma_f32_32x32x16_bf16 v[64:79], v[164:167], v[52:55], v[64:79]
  ds_read_b128 v[100:103], v2 offset:13312
  v_mul_f32 v24, 0x3b000000, v24
  s_waitcnt lgkmcnt(2)
  v_mfma_f32_32x32x16_bf16 v[64:79], v[168:171], v[56:59], v[64:79]
  ds_read_b128 v[104:107], v2 offset:14336
  buffer_load_dwordx4 v2, s[48:51], s8 offen offset:3072 sc1 lds
  v_mul_f32 v25, 0x3b000000, v25
  v_mfma_f32_32x32x16_bf16 v[64:79], v[172:175], v[60:63], v[64:79]
  ds_read_b128 v[108:111], v2 offset:15360
  v_fma_f32 v25, -v24, v24, v25
  s_add_u32 m0, s9, 65536
  s_add_u32 s8, s96, 65536
  buffer_load_dwordx4 v2, s[48:51], s8 offen offset:0 sc1 lds
  s_waitcnt lgkmcnt(2)
  v_mfma_f32_32x32x16_bf16 v[64:79], v[176:179], v[96:99], v[64:79]
  ds_read_b128 v[48:51], v2 offset:16384
  v_max_f32 v25, 0, v25
  v_mfma_f32_32x32x16_bf16 v[64:79], v[180:183], v[100:103], v[64:79]
  ds_read_b128 v[52:55], v2 offset:17408
  v_cvt_pk_bf16_f32 v26, v24, v25
  buffer_load_dwordx4 v2, s[48:51], s8 offen offset:1024 sc1 lds
  s_waitcnt lgkmcnt(2)
  v_mfma_f32_32x32x16_bf16 v[64:79], v[184:187], v[104:107], v[64:79]
  ds_read_b128 v[56:59], v2 offset:18432
  v_lshlrev_b32 v28, 16, v26
  v_mfma_f32_32x32x16_bf16 v[64:79], v[188:191], v[108:111], v[64:79]
  ds_read_b128 v[60:63], v2 offset:19456
  v_and_b32 v26, s69, v26
  buffer_load_dwordx4 v2, s[48:51], s8 offen offset:2048 sc1 lds
  s_waitcnt lgkmcnt(2)
  v_mfma_f32_32x32x16_bf16 v[64:79], v[192:195], v[48:51], v[64:79]
  ds_read_b128 v[96:99], v2 offset:20480
  v_add_f32 v26, 0x3727c5ac, v26
  v_mfma_f32_32x32x16_bf16 v[64:79], v[196:199], v[52:55], v[64:79]
  ds_read_b128 v[100:103], v2 offset:21504
  v_cvt_pk_bf16_f32 v26, v26, v26
  buffer_load_dwordx4 v2, s[48:51], s8 offen offset:3072 sc1 lds
  s_waitcnt lgkmcnt(2)
  v_mfma_f32_32x32x16_bf16 v[64:79], v[200:203], v[56:59], v[64:79]
  ds_read_b128 v[104:107], v2 offset:22528
  v_and_b32 v26, s69, v26
  v_sqrt_f32 v26, v26
  v_mfma_f32_32x32x16_bf16 v[64:79], v[204:207], v[60:63], v[64:79]
  ds_read_b128 v[108:111], v2 offset:23552
  s_add_u32 m0, s9, 69632
  s_add_u32 s8, s96, 69632
  buffer_load_dwordx4 v2, s[48:51], s8 offen offset:0 sc1 lds
  s_waitcnt lgkmcnt(2)
  v_mfma_f32_32x32x16_bf16 v[64:79], v[208:211], v[96:99], v[64:79]
  ds_read_b128 v[48:51], v2 offset:24576
  v_cvt_pk_bf16_f32 v26, v26, v26
  v_and_b32 v29, s69, v26
  v_mfma_f32_32x32x16_bf16 v[64:79], v[212:215], v[100:103], v[64:79]
  ds_read_b128 v[52:55], v2 offset:25600
  buffer_load_dwordx4 v2, s[48:51], s8 offen offset:1024 sc1 lds
  s_waitcnt lgkmcnt(2)
  v_mfma_f32_32x32x16_bf16 v[64:79], v[216:219], v[104:107], v[64:79]
  ds_read_b128 v[56:59], v2 offset:26624
  ds_write_b64 v23, v[28:29]
  v_mfma_f32_32x32x16_bf16 v[64:79], v[220:223], v[108:111], v[64:79]
  ds_read_b128 v[60:63], v2 offset:27648
  buffer_load_dwordx4 v2, s[48:51], s8 offen offset:2048 sc1 lds
  buffer_load_dwordx4 v2, s[48:51], s8 offen offset:3072 sc1 lds
  s_waitcnt lgkmcnt(3)
  v_mfma_f32_32x32x16_bf16 v[64:79], v[224:227], v[48:51], v[64:79]
  ds_read_b128 v[96:99], v2 offset:28672
  v_mfma_f32_32x32x16_bf16 v[64:79], v[228:231], v[52:55], v[64:79]
  ds_read_b128 v[100:103], v2 offset:29696
  s_waitcnt vmcnt(8) lgkmcnt(3)
  s_barrier
  ds_read_b64 v[12:13], v22 offset:0
  ds_read_b64 v[14:15], v22 offset:256
  ds_read_b64 v[16:17], v22 offset:512
  ds_read_b64 v[18:19], v22 offset:768
  s_waitcnt lgkmcnt(6)
  v_mfma_f32_32x32x16_bf16 v[64:79], v[232:235], v[56:59], v[64:79]
  ds_read_b128 v[104:107], v2 offset:30720
  v_mfma_f32_32x32x16_bf16 v[64:79], v[236:239], v[60:63], v[64:79]
  ds_read_b128 v[108:111], v2 offset:31744
  s_waitcnt lgkmcnt(6)
  v_mfma_f32_32x32x16_bf16 v[64:79], v[240:243], v[96:99], v[64:79]
  ds_read_b128 v[48:51], v2 offset:32768
  v_mfma_f32_32x32x16_bf16 v[64:79], v[244:247], v[100:103], v[64:79]
  ds_read_b128 v[52:55], v2 offset:33792
  s_waitcnt lgkmcnt(2)
  v_cvt_pk_bf16_f32 v44, -v12, -v12
  v_cvt_pk_bf16_f32 v45, -v12, 0
  v_cndmask_b32 v44, 0, v44, s[14:15]
  v_cndmask_b32 v45, 0, v45, s[14:15]
  s_waitcnt lgkmcnt(2)
  v_mfma_f32_32x32x16_bf16 v[64:79], v[248:251], v[104:107], v[64:79]
  ds_read_b128 v[56:59], v2 offset:34816
  v_mfma_f32_32x32x16_bf16 v[64:79], v[252:255], v[108:111], v[64:79]
  ds_read_b128 v[60:63], v2 offset:35840
  v_mfma_f32_32x32x16_bf16 v[64:79], v[8:11], v[44:47], v[64:79]
  s_waitcnt lgkmcnt(2)
  v_mfma_f32_32x32x16_bf16 v[80:95], v[128:131], v[48:51], 0
  ds_read_b128 v[112:115], v2 offset:36864
  v_mfma_f32_32x32x16_bf16 v[80:95], v[132:135], v[52:55], v[80:95]
  ds_read_b128 v[116:119], v2 offset:37888
  v_cvt_pk_bf16_f32 v44, -v14, -v14
  v_cvt_pk_bf16_f32 v45, -v14, 0
  v_cndmask_b32 v44, 0, v44, s[14:15]
  v_cndmask_b32 v45, 0, v45, s[14:15]
  s_waitcnt lgkmcnt(2)
  v_mfma_f32_32x32x16_bf16 v[80:95], v[136:139], v[56:59], v[80:95]
  ds_read_b128 v[120:123], v2 offset:38912
  v_rcp_f32 v24, v13
s_nop 0
  v_mul_f32 v20, 0xc0135761, v24
  v_mul_f32 v24, v24, v24
  v_mul_f32 v24, 0x3d372713, v24
  v_mul_f32 v21, v24, v20
  v_mfma_f32_32x32x16_bf16 v[80:95], v[140:143], v[60:63], v[80:95]
  ds_read_b128 v[124:127], v2 offset:39936
  v_mul_f32 v24, v64, v64
  v_mul_f32 v25, v65, v65
  s_add_u32 m0, s9, 98304
  s_add_u32 s8, s96, 98304
  buffer_load_dwordx4 v2, s[48:51], s8 offen offset:0 sc1 lds
  v_mul_f32 v26, v66, v66
  v_mul_f32 v27, v67, v67
  s_waitcnt lgkmcnt(2)
  v_mfma_f32_32x32x16_bf16 v[80:95], v[144:147], v[112:115], v[80:95]
  ds_read_b128 v[48:51], v2 offset:40960
  v_fma_f32 v24, v24, v21, v20
  v_fma_f32 v25, v25, v21, v20
  v_fma_f32 v26, v26, v21, v20
  v_fma_f32 v27, v27, v21, v20
  v_mfma_f32_32x32x16_bf16 v[80:95], v[148:151], v[116:119], v[80:95]
  ds_read_b128 v[52:55], v2 offset:41984
  v_mul_f32 v24, v24, v64
  v_exp_f32 v24, v24
  v_mul_f32 v25, v25, v65
  v_mul_f32 v26, v26, v66
  v_exp_f32 v25, v25
  s_waitcnt lgkmcnt(2)
  v_mfma_f32_32x32x16_bf16 v[80:95], v[152:155], v[120:123], v[80:95]
  ds_read_b128 v[56:59], v2 offset:43008
  buffer_load_dwordx4 v2, s[48:51], s8 offen offset:1024 sc1 lds
  v_mul_f32 v27, v27, v67
  v_fma_f32 v24, v24, v13, v13
  v_exp_f32 v26, v26
  v_fma_f32 v25, v25, v13, v13
  v_mfma_f32_32x32x16_bf16 v[80:95], v[156:159], v[124:127], v[80:95]
  ds_read_b128 v[60:63], v2 offset:44032
  v_fma_f32 v26, v26, v13, v13
  v_exp_f32 v27, v27
  v_mul_f32 v40, v68, v68
  v_fma_f32 v27, v27, v13, v13
  v_rcp_f32 v24, v24
  s_waitcnt lgkmcnt(2)
  v_mfma_f32_32x32x16_bf16 v[80:95], v[160:163], v[48:51], v[80:95]
  ds_read_b128 v[112:115], v2 offset:45056
  v_mul_f32 v41, v69, v69
  v_mul_f32 v24, v24, v64
  buffer_load_dwordx4 v2, s[48:51], s8 offen offset:2048 sc1 lds
  v_rcp_f32 v25, v25
  v_mfma_f32_32x32x16_bf16 v[80:95], v[164:167], v[52:55], v[80:95]
  ds_read_b128 v[116:119], v2 offset:46080
  v_mul_f32 v42, v70, v70
  v_mul_f32 v25, v25, v65
  v_rcp_f32 v26, v26
  v_cvt_pk_bf16_f32 v28, v24, v25
  v_mul_f32 v26, v26, v66
  s_waitcnt lgkmcnt(2)
  v_mfma_f32_32x32x16_bf16 v[80:95], v[168:171], v[56:59], v[80:95]
  ds_read_b128 v[120:123], v2 offset:47104
  v_rcp_f32 v27, v27
  v_mul_f32 v43, v71, v71
  v_mul_f32 v27, v27, v67
  v_cvt_pk_bf16_f32 v29, v26, v27
  v_fma_f32 v40, v40, v21, v20
  v_mfma_f32_32x32x16_bf16 v[80:95], v[172:175], v[60:63], v[80:95]
  ds_read_b128 v[124:127], v2 offset:48128
  buffer_load_dwordx4 v2, s[48:51], s8 offen offset:3072 sc1 lds
  v_fma_f32 v41, v41, v21, v20
  v_fma_f32 v42, v42, v21, v20
  v_fma_f32 v43, v43, v21, v20
  v_mul_f32 v40, v40, v68
  s_waitcnt lgkmcnt(2)
  v_mfma_f32_32x32x16_bf16 v[80:95], v[176:179], v[112:115], v[80:95]
  ds_read_b128 v[48:51], v2 offset:49152
  v_exp_f32 v40, v40
  v_mul_f32 v41, v41, v69
  v_mul_f32 v42, v42, v70
  v_exp_f32 v41, v41
  v_mfma_f32_32x32x16_bf16 v[80:95], v[180:183], v[116:119], v[80:95]
  ds_read_b128 v[52:55], v2 offset:50176
  v_mul_f32 v43, v43, v71
  v_fma_f32 v40, v40, v13, v13
  v_exp_f32 v42, v42
  s_add_u32 m0, s9, 102400
  s_add_u32 s8, s96, 102400
  buffer_load_dwordx4 v2, s[48:51], s8 offen offset:0 sc1 lds
  v_fma_f32 v41, v41, v13, v13
  s_waitcnt lgkmcnt(2)
  v_mfma_f32_32x32x16_bf16 v[80:95], v[184:187], v[120:123], v[80:95]
  ds_read_b128 v[56:59], v2 offset:51200
  v_fma_f32 v42, v42, v13, v13
  v_exp_f32 v43, v43
  v_mul_f32 v24, v72, v72
  v_fma_f32 v43, v43, v13, v13
  v_rcp_f32 v40, v40
  v_mfma_f32_32x32x16_bf16 v[80:95], v[188:191], v[124:127], v[80:95]
  ds_read_b128 v[60:63], v2 offset:52224
  v_mul_f32 v25, v73, v73
  v_mul_f32 v40, v40, v68
  v_rcp_f32 v41, v41
  v_mul_f32 v26, v74, v74
  v_mul_f32 v41, v41, v69
  s_waitcnt lgkmcnt(2)
  v_mfma_f32_32x32x16_bf16 v[80:95], v[192:195], v[48:51], v[80:95]
  ds_read_b128 v[112:115], v2 offset:53248
  buffer_load_dwordx4 v2, s[48:51], s8 offen offset:1024 sc1 lds
  v_rcp_f32 v42, v42
  v_cvt_pk_bf16_f32 v30, v40, v41
  v_mul_f32 v42, v42, v70
  v_mfma_f32_32x32x16_bf16 v[80:95], v[196:199], v[52:55], v[80:95]
  ds_read_b128 v[116:119], v2 offset:54272
  v_rcp_f32 v43, v43
  v_mul_f32 v27, v75, v75
  v_mul_f32 v43, v43, v71
  v_cvt_pk_bf16_f32 v31, v42, v43
  s_add_u32 s10, s97, 0
  buffer_store_dwordx4 v[28:31], v2, s[48:51], s10 offen sc1
  s_waitcnt lgkmcnt(2)
  v_mfma_f32_32x32x16_bf16 v[80:95], v[200:203], v[56:59], v[80:95]
  ds_read_b128 v[120:123], v2 offset:55296
  v_fma_f32 v24, v24, v21, v20
  v_fma_f32 v25, v25, v21, v20
  v_fma_f32 v26, v26, v21, v20
  buffer_load_dwordx4 v2, s[48:51], s8 offen offset:2048 sc1 lds
  v_fma_f32 v27, v27, v21, v20
  v_mfma_f32_32x32x16_bf16 v[80:95], v[204:207], v[60:63], v[80:95]
  ds_read_b128 v[124:127], v2 offset:56320
  v_mul_f32 v24, v24, v72
  v_exp_f32 v24, v24
  v_mul_f32 v25, v25, v73
  v_mul_f32 v26, v26, v74
  s_waitcnt lgkmcnt(2)
  v_mfma_f32_32x32x16_bf16 v[80:95], v[208:211], v[112:115], v[80:95]
  ds_read_b128 v[48:51], v2 offset:57344
  v_exp_f32 v25, v25
  v_mul_f32 v27, v27, v75
  v_fma_f32 v24, v24, v13, v13
  v_exp_f32 v26, v26
  v_fma_f32 v25, v25, v13, v13
  v_mfma_f32_32x32x16_bf16 v[80:95], v[212:215], v[116:119], v[80:95]
  ds_read_b128 v[52:55], v2 offset:58368
  v_fma_f32 v26, v26, v13, v13
  buffer_load_dwordx4 v2, s[48:51], s8 offen offset:3072 sc1 lds
  v_exp_f32 v27, v27
  v_mul_f32 v40, v76, v76
  v_fma_f32 v27, v27, v13, v13
  s_waitcnt lgkmcnt(2)
  v_mfma_f32_32x32x16_bf16 v[80:95], v[216:219], v[120:123], v[80:95]
  ds_read_b128 v[56:59], v2 offset:59392
  v_rcp_f32 v24, v24
  v_mul_f32 v41, v77, v77
  v_mul_f32 v24, v24, v72
  v_rcp_f32 v25, v25
  v_mul_f32 v42, v78, v78
  v_mfma_f32_32x32x16_bf16 v[80:95], v[220:223], v[124:127], v[80:95]
  ds_read_b128 v[60:63], v2 offset:60416
  v_mul_f32 v25, v25, v73
  v_rcp_f32 v26, v26
  v_cvt_pk_bf16_f32 v32, v24, v25
  buffer_load_dwordx4 a[88:91], v2, s[48:51], s46 offen offset:3072 sc1
  s_waitcnt lgkmcnt(2)
  v_mfma_f32_32x32x16_bf16 v[80:95], v[224:227], v[48:51], v[80:95]
  ds_read_b128 v[112:115], v2 offset:61440
  v_mul_f32 v26, v26, v74
  v_rcp_f32 v27, v27
  v_mul_f32 v43, v79, v79
  v_mul_f32 v27, v27, v75
  v_cvt_pk_bf16_f32 v33, v26, v27
  v_mfma_f32_32x32x16_bf16 v[80:95], v[228:231], v[52:55], v[80:95]
  ds_read_b128 v[116:119], v2 offset:62464
  v_fma_f32 v40, v40, v21, v20
  v_fma_f32 v41, v41, v21, v20
  v_fma_f32 v42, v42, v21, v20
  v_fma_f32 v43, v43, v21, v20
  v_mul_f32 v40, v40, v76
  s_waitcnt vmcnt(10)
  s_barrier
  s_waitcnt lgkmcnt(2)
  v_mfma_f32_32x32x16_bf16 v[80:95], v[232:235], v[56:59], v[80:95]
  ds_read_b128 v[120:123], v2 offset:63488
  v_exp_f32 v40, v40
  buffer_load_dwordx4 a[92:95], v2, s[48:51], s47 offen offset:3072 sc1
  v_mul_f32 v41, v41, v77
  v_mul_f32 v42, v42, v78
  v_exp_f32 v41, v41
  v_mfma_f32_32x32x16_bf16 v[80:95], v[236:239], v[60:63], v[80:95]
  ds_read_b128 v[124:127], v2 offset:64512
  v_mul_f32 v43, v43, v79
  v_fma_f32 v40, v40, v13, v13
  v_exp_f32 v42, v42
  v_fma_f32 v41, v41, v13, v13
  s_waitcnt lgkmcnt(2)
  v_mfma_f32_32x32x16_bf16 v[80:95], v[240:243], v[112:115], v[80:95]
  ds_read_b128 v[48:51], v5 offset:0
  v_fma_f32 v42, v42, v13, v13
  v_exp_f32 v43, v43
  v_rcp_f32 v40, v40
  v_fma_f32 v43, v43, v13, v13
  s_add_u32 s46, s91, 12288
  buffer_load_dwordx4 a[96:99], v2, s[48:51], s46 offen offset:0 sc1
  v_mfma_f32_32x32x16_bf16 v[80:95], v[244:247], v[116:119], v[80:95]
  ds_read_b128 v[52:55], v5 offset:1024
  v_mul_f32 v40, v40, v76
  v_rcp_f32 v41, v41
  v_rcp_f32 v42, v42
  v_mul_f32 v41, v41, v77
  v_mul_f32 v42, v42, v78
  s_waitcnt lgkmcnt(2)
  v_mfma_f32_32x32x16_bf16 v[80:95], v[248:251], v[120:123], v[80:95]
  ds_read_b128 v[56:59], v5 offset:2048
  v_rcp_f32 v43, v43
  v_cvt_pk_bf16_f32 v34, v40, v41
  v_mul_f32 v43, v43, v79
  v_cvt_pk_bf16_f32 v35, v42, v43
  buffer_store_dwordx4 v[32:35], v2, s[48:51], s10 offen offset:1024 sc1
  v_mfma_f32_32x32x16_bf16 v[80:95], v[252:255], v[124:127], v[80:95]
  ds_read_b128 v[60:63], v5 offset:3072
  v_mfma_f32_32x32x16_bf16 v[80:95], v[8:11], v[44:47], v[80:95]
  s_waitcnt lgkmcnt(2)
  v_mfma_f32_32x32x16_bf16 v[96:111], v[128:131], v[48:51], 0
  ds_read_b128 v[64:67], v5 offset:4096
  v_mfma_f32_32x32x16_bf16 v[96:111], v[132:135], v[52:55], v[96:111]
  ds_read_b128 v[68:71], v5 offset:5120
  v_cvt_pk_bf16_f32 v44, -v16, -v16
  v_cvt_pk_bf16_f32 v45, -v16, 0
  v_cndmask_b32 v44, 0, v44, s[14:15]
  v_cndmask_b32 v45, 0, v45, s[14:15]
  s_waitcnt lgkmcnt(2)
  v_mfma_f32_32x32x16_bf16 v[96:111], v[136:139], v[56:59], v[96:111]
  ds_read_b128 v[72:75], v5 offset:6144
  v_rcp_f32 v24, v15
s_nop 0
  v_mul_f32 v20, 0xc0135761, v24
  v_mul_f32 v24, v24, v24
  v_mul_f32 v24, 0x3d372713, v24
  v_mul_f32 v21, v24, v20
  v_mfma_f32_32x32x16_bf16 v[96:111], v[140:143], v[60:63], v[96:111]
  ds_read_b128 v[76:79], v5 offset:7168
  v_mul_f32 v24, v80, v80
  v_mul_f32 v25, v81, v81
  s_add_u32 s47, s92, 12288
  buffer_load_dwordx4 a[100:103], v2, s[48:51], s47 offen offset:0 sc1
  v_mul_f32 v26, v82, v82
  v_mul_f32 v27, v83, v83
  s_waitcnt lgkmcnt(2)
  v_mfma_f32_32x32x16_bf16 v[96:111], v[144:147], v[64:67], v[96:111]
  ds_read_b128 v[48:51], v5 offset:8192
  v_fma_f32 v24, v24, v21, v20
  v_fma_f32 v25, v25, v21, v20
  v_fma_f32 v26, v26, v21, v20
  v_fma_f32 v27, v27, v21, v20
  v_mul_f32 v24, v24, v80
  v_mfma_f32_32x32x16_bf16 v[96:111], v[148:151], v[68:71], v[96:111]
  ds_read_b128 v[52:55], v5 offset:9216
  v_exp_f32 v24, v24
  v_mul_f32 v25, v25, v81
  v_mul_f32 v26, v26, v82
  v_exp_f32 v25, v25
  s_waitcnt lgkmcnt(2)
  v_mfma_f32_32x32x16_bf16 v[96:111], v[152:155], v[72:75], v[96:111]
  ds_read_b128 v[56:59], v5 offset:10240
  buffer_load_dwordx4 a[104:107], v2, s[48:51], s46 offen offset:1024 sc1
  v_mul_f32 v27, v27, v83
  v_fma_f32 v24, v24, v15, v15
  v_exp_f32 v26, v26
  v_fma_f32 v25, v25, v15, v15
  v_mfma_f32_32x32x16_bf16 v[96:111], v[156:159], v[76:79], v[96:111]
  ds_read_b128 v[60:63], v5 offset:11264
  v_fma_f32 v26, v26, v15, v15
  v_exp_f32 v27, v27
  v_mul_f32 v40, v84, v84
  v_fma_f32 v27, v27, v15, v15
  v_rcp_f32 v24, v24
  s_waitcnt lgkmcnt(2)
  v_mfma_f32_32x32x16_bf16 v[96:111], v[160:163], v[48:51], v[96:111]
  ds_read_b128 v[64:67], v5 offset:12288
  v_mul_f32 v41, v85, v85
  v_mul_f32 v24, v24, v80
  buffer_load_dwordx4 a[108:111], v2, s[48:51], s47 offen offset:1024 sc1
  v_rcp_f32 v25, v25
  v_mul_f32 v42, v86, v86
  v_mfma_f32_32x32x16_bf16 v[96:111], v[164:167], v[52:55], v[96:111]
  ds_read_b128 v[68:71], v5 offset:13312
  v_mul_f32 v25, v25, v81
  v_rcp_f32 v26, v26
  v_cvt_pk_bf16_f32 v28, v24, v25
  v_mul_f32 v26, v26, v82
  s_waitcnt lgkmcnt(2)
  v_mfma_f32_32x32x16_bf16 v[96:111], v[168:171], v[56:59], v[96:111]
  ds_read_b128 v[72:75], v5 offset:14336
  v_rcp_f32 v27, v27
  v_mul_f32 v43, v87, v87
  v_mul_f32 v27, v27, v83
  v_cvt_pk_bf16_f32 v29, v26, v27
  v_fma_f32 v40, v40, v21, v20
  v_mfma_f32_32x32x16_bf16 v[96:111], v[172:175], v[60:63], v[96:111]
  ds_read_b128 v[76:79], v5 offset:15360
  buffer_load_dwordx4 a[112:115], v2, s[48:51], s46 offen offset:2048 sc1
  v_fma_f32 v41, v41, v21, v20
  v_fma_f32 v42, v42, v21, v20
  v_fma_f32 v43, v43, v21, v20
  v_mul_f32 v40, v40, v84
  s_waitcnt lgkmcnt(2)
  v_mfma_f32_32x32x16_bf16 v[96:111], v[176:179], v[64:67], v[96:111]
  ds_read_b128 v[48:51], v5 offset:16384
  v_exp_f32 v40, v40
  v_mul_f32 v41, v41, v85
  v_mul_f32 v42, v42, v86
  v_exp_f32 v41, v41
  v_mul_f32 v43, v43, v87
  v_mfma_f32_32x32x16_bf16 v[96:111], v[180:183], v[68:71], v[96:111]
  ds_read_b128 v[52:55], v5 offset:17408
  v_fma_f32 v40, v40, v15, v15
  v_exp_f32 v42, v42
  buffer_load_dwordx4 a[116:119], v2, s[48:51], s47 offen offset:2048 sc1
  s_waitcnt vmcnt(5)
  s_add_u32 s8, s97, 0
  buffer_load_dwordx4 v[36:39], v2, s[48:51], s8 offen sc1
  buffer_load_dwordx4 v[36:39], v2, s[48:51], s8 offen offset:1024 sc1
  s_waitcnt lgkmcnt(2)
  v_mfma_f32_32x32x16_bf16 v[96:111], v[184:187], v[72:75], v[96:111]
  ds_read_b128 v[56:59], v5 offset:18432
  v_fma_f32 v41, v41, v15, v15
  v_fma_f32 v42, v42, v15, v15
  v_exp_f32 v43, v43
  v_mul_f32 v24, v88, v88
  v_fma_f32 v43, v43, v15, v15
  v_mfma_f32_32x32x16_bf16 v[96:111], v[188:191], v[76:79], v[96:111]
  ds_read_b128 v[60:63], v5 offset:19456
  v_rcp_f32 v40, v40
  v_mul_f32 v25, v89, v89
  v_mul_f32 v40, v40, v84
  v_rcp_f32 v41, v41
  v_mul_f32 v26, v90, v90
  s_waitcnt lgkmcnt(2)
  v_mfma_f32_32x32x16_bf16 v[96:111], v[192:195], v[48:51], v[96:111]
  ds_read_b128 v[64:67], v5 offset:20480
  v_mul_f32 v41, v41, v85
  buffer_load_dwordx4 a[120:123], v2, s[48:51], s46 offen offset:3072 sc1
  v_rcp_f32 v42, v42
  v_cvt_pk_bf16_f32 v30, v40, v41
  v_mul_f32 v42, v42, v86
  v_mfma_f32_32x32x16_bf16 v[96:111], v[196:199], v[52:55], v[96:111]
  ds_read_b128 v[68:71], v5 offset:21504
  v_rcp_f32 v43, v43
  v_mul_f32 v27, v91, v91
  v_mul_f32 v43, v43, v87
  v_cvt_pk_bf16_f32 v31, v42, v43
  s_add_u32 s10, s97, 114688
  buffer_store_dwordx4 v[28:31], v2, s[48:51], s10 offen sc1
  s_waitcnt lgkmcnt(2)
  v_mfma_f32_32x32x16_bf16 v[96:111], v[200:203], v[56:59], v[96:111]
  ds_read_b128 v[72:75], v5 offset:22528
  v_fma_f32 v24, v24, v21, v20
  v_fma_f32 v25, v25, v21, v20
  v_fma_f32 v26, v26, v21, v20
  buffer_load_dwordx4 a[124:127], v2, s[48:51], s47 offen offset:3072 sc1
  v_mfma_f32_32x32x16_bf16 v[96:111], v[204:207], v[60:63], v[96:111]
  ds_read_b128 v[76:79], v5 offset:23552
  v_fma_f32 v27, v27, v21, v20
  v_mul_f32 v24, v24, v88
  v_exp_f32 v24, v24
  v_mul_f32 v25, v25, v89
  v_mul_f32 v26, v26, v90
  s_waitcnt lgkmcnt(2)
  v_mfma_f32_32x32x16_bf16 v[96:111], v[208:211], v[64:67], v[96:111]
  ds_read_b128 v[48:51], v5 offset:24576
  v_exp_f32 v25, v25
  v_mul_f32 v27, v27, v91
  v_fma_f32 v24, v24, v15, v15
  v_exp_f32 v26, v26
  v_fma_f32 v25, v25, v15, v15
  v_mfma_f32_32x32x16_bf16 v[96:111], v[212:215], v[68:71], v[96:111]
  ds_read_b128 v[52:55], v5 offset:25600
  v_fma_f32 v26, v26, v15, v15
  s_add_u32 s46, s91, 16384
  buffer_load_dwordx4 a[128:131], v2, s[48:51], s46 offen offset:0 sc1
  v_exp_f32 v27, v27
  v_mul_f32 v40, v92, v92
  v_fma_f32 v27, v27, v15, v15
  s_waitcnt lgkmcnt(2)
  v_mfma_f32_32x32x16_bf16 v[96:111], v[216:219], v[72:75], v[96:111]
  ds_read_b128 v[56:59], v5 offset:26624
  v_rcp_f32 v24, v24
  v_mul_f32 v41, v93, v93
  v_mul_f32 v24, v24, v88
  v_rcp_f32 v25, v25
  v_mfma_f32_32x32x16_bf16 v[96:111], v[220:223], v[76:79], v[96:111]
  ds_read_b128 v[60:63], v5 offset:27648
  v_mul_f32 v42, v94, v94
  v_mul_f32 v25, v25, v89
  v_rcp_f32 v26, v26
  v_cvt_pk_bf16_f32 v32, v24, v25
  s_add_u32 s47, s92, 16384
  buffer_load_dwordx4 a[132:135], v2, s[48:51], s47 offen offset:0 sc1
  s_waitcnt lgkmcnt(2)
  v_mfma_f32_32x32x16_bf16 v[96:111], v[224:227], v[48:51], v[96:111]
  ds_read_b128 v[64:67], v5 offset:28672
  v_mul_f32 v26, v26, v90
  v_rcp_f32 v27, v27
  v_mul_f32 v43, v95, v95
  v_mul_f32 v27, v27, v91
  v_cvt_pk_bf16_f32 v33, v26, v27
  v_mfma_f32_32x32x16_bf16 v[96:111], v[228:231], v[52:55], v[96:111]
  ds_read_b128 v[68:71], v5 offset:29696
  v_fma_f32 v40, v40, v21, v20
  v_fma_f32 v41, v41, v21, v20
  v_fma_f32 v42, v42, v21, v20
  v_fma_f32 v43, v43, v21, v20
  v_mul_f32 v40, v40, v92
  s_waitcnt vmcnt(16)
  s_barrier
  s_waitcnt lgkmcnt(2)
  v_mfma_f32_32x32x16_bf16 v[96:111], v[232:235], v[56:59], v[96:111]
  ds_read_b128 v[72:75], v5 offset:30720
  v_exp_f32 v40, v40
  buffer_load_dwordx4 a[136:139], v2, s[48:51], s46 offen offset:1024 sc1
  v_mul_f32 v41, v41, v93
  v_mul_f32 v42, v42, v94
  v_mfma_f32_32x32x16_bf16 v[96:111], v[236:239], v[60:63], v[96:111]
  ds_read_b128 v[76:79], v5 offset:31744
  v_exp_f32 v41, v41
  v_mul_f32 v43, v43, v95
  v_fma_f32 v40, v40, v15, v15
  v_exp_f32 v42, v42
  v_fma_f32 v41, v41, v15, v15
  s_waitcnt lgkmcnt(2)
  v_mfma_f32_32x32x16_bf16 v[96:111], v[240:243], v[64:67], v[96:111]
  ds_read_b128 v[48:51], v5 offset:32768
  v_fma_f32 v42, v42, v15, v15
  v_exp_f32 v43, v43
  v_rcp_f32 v40, v40
  v_fma_f32 v43, v43, v15, v15
  buffer_load_dwordx4 a[140:143], v2, s[48:51], s47 offen offset:1024 sc1
  v_mfma_f32_32x32x16_bf16 v[96:111], v[244:247], v[68:71], v[96:111]
  ds_read_b128 v[52:55], v5 offset:33792
  v_mul_f32 v40, v40, v92
  v_rcp_f32 v41, v41
  v_rcp_f32 v42, v42
  v_mul_f32 v41, v41, v93
  v_mul_f32 v42, v42, v94
  s_waitcnt lgkmcnt(2)
  v_mfma_f32_32x32x16_bf16 v[96:111], v[248:251], v[72:75], v[96:111]
  ds_read_b128 v[56:59], v5 offset:34816
  v_rcp_f32 v43, v43
  v_cvt_pk_bf16_f32 v34, v40, v41
  v_mul_f32 v43, v43, v95
  v_cvt_pk_bf16_f32 v35, v42, v43
  buffer_store_dwordx4 v[32:35], v2, s[48:51], s10 offen offset:1024 sc1
  v_mfma_f32_32x32x16_bf16 v[96:111], v[252:255], v[76:79], v[96:111]
  ds_read_b128 v[60:63], v5 offset:35840
  v_mfma_f32_32x32x16_bf16 v[96:111], v[8:11], v[44:47], v[96:111]
  s_waitcnt lgkmcnt(2)
  v_mfma_f32_32x32x16_bf16 v[112:127], v[128:131], v[48:51], 0
  ds_read_b128 v[80:83], v5 offset:36864
  v_mfma_f32_32x32x16_bf16 v[112:127], v[132:135], v[52:55], v[112:127]
  ds_read_b128 v[84:87], v5 offset:37888
  v_cvt_pk_bf16_f32 v44, -v18, -v18
  v_cvt_pk_bf16_f32 v45, -v18, 0
  v_cndmask_b32 v44, 0, v44, s[14:15]
  v_cndmask_b32 v45, 0, v45, s[14:15]
  s_waitcnt lgkmcnt(2)
  v_mfma_f32_32x32x16_bf16 v[112:127], v[136:139], v[56:59], v[112:127]
  ds_read_b128 v[88:91], v5 offset:38912
  v_rcp_f32 v24, v17
s_nop 0
  v_mul_f32 v20, 0xc0135761, v24
  v_mul_f32 v24, v24, v24
  v_mul_f32 v24, 0x3d372713, v24
  v_mul_f32 v21, v24, v20
  v_mfma_f32_32x32x16_bf16 v[112:127], v[140:143], v[60:63], v[112:127]
  ds_read_b128 v[92:95], v5 offset:39936
  v_mul_f32 v24, v96, v96
  v_mul_f32 v25, v97, v97
  buffer_load_dwordx4 a[144:147], v2, s[48:51], s46 offen offset:2048 sc1
  v_mul_f32 v26, v98, v98
  v_mul_f32 v27, v99, v99
  s_waitcnt lgkmcnt(2)
  v_mfma_f32_32x32x16_bf16 v[112:127], v[144:147], v[80:83], v[112:127]
  ds_read_b128 v[48:51], v5 offset:40960
  v_fma_f32 v24, v24, v21, v20
  v_fma_f32 v25, v25, v21, v20
  v_fma_f32 v26, v26, v21, v20
  v_fma_f32 v27, v27, v21, v20
  v_mul_f32 v24, v24, v96
  v_mfma_f32_32x32x16_bf16 v[112:127], v[148:151], v[84:87], v[112:127]
  ds_read_b128 v[52:55], v5 offset:41984
  v_exp_f32 v24, v24
  v_mul_f32 v25, v25, v97
  v_mul_f32 v26, v26, v98
  v_exp_f32 v25, v25
  s_waitcnt lgkmcnt(2)
  v_mfma_f32_32x32x16_bf16 v[112:127], v[152:155], v[88:91], v[112:127]
  ds_read_b128 v[56:59], v5 offset:43008
  buffer_load_dwordx4 a[148:151], v2, s[48:51], s47 offen offset:2048 sc1
  v_mul_f32 v27, v27, v99
  v_fma_f32 v24, v24, v17, v17
  v_exp_f32 v26, v26
  v_fma_f32 v25, v25, v17, v17
  v_mfma_f32_32x32x16_bf16 v[112:127], v[156:159], v[92:95], v[112:127]
  ds_read_b128 v[60:63], v5 offset:44032
  v_fma_f32 v26, v26, v17, v17
  v_exp_f32 v27, v27
  v_mul_f32 v40, v100, v100
  v_fma_f32 v27, v27, v17, v17
  v_rcp_f32 v24, v24
  s_waitcnt lgkmcnt(2)
  v_mfma_f32_32x32x16_bf16 v[112:127], v[160:163], v[48:51], v[112:127]
  ds_read_b128 v[80:83], v5 offset:45056
  v_mul_f32 v41, v101, v101
  v_mul_f32 v24, v24, v96
  buffer_load_dwordx4 a[152:155], v2, s[48:51], s46 offen offset:3072 sc1
  v_rcp_f32 v25, v25
  v_mul_f32 v42, v102, v102
  v_mfma_f32_32x32x16_bf16 v[112:127], v[164:167], v[52:55], v[112:127]
  ds_read_b128 v[84:87], v5 offset:46080
  v_mul_f32 v25, v25, v97
  v_rcp_f32 v26, v26
  v_cvt_pk_bf16_f32 v28, v24, v25
  v_mul_f32 v26, v26, v98
  s_waitcnt lgkmcnt(2)
  v_mfma_f32_32x32x16_bf16 v[112:127], v[168:171], v[56:59], v[112:127]
  ds_read_b128 v[88:91], v5 offset:47104
  v_rcp_f32 v27, v27
  v_mul_f32 v43, v103, v103
  v_mul_f32 v27, v27, v99
  v_cvt_pk_bf16_f32 v29, v26, v27
  v_fma_f32 v40, v40, v21, v20
  v_mfma_f32_32x32x16_bf16 v[112:127], v[172:175], v[60:63], v[112:127]
  ds_read_b128 v[92:95], v5 offset:48128
  buffer_load_dwordx4 a[156:159], v2, s[48:51], s47 offen offset:3072 sc1
  v_fma_f32 v41, v41, v21, v20
  v_fma_f32 v42, v42, v21, v20
  v_fma_f32 v43, v43, v21, v20
  v_mul_f32 v40, v40, v100
  s_waitcnt lgkmcnt(2)
  v_mfma_f32_32x32x16_bf16 v[112:127], v[176:179], v[80:83], v[112:127]
  ds_read_b128 v[48:51], v5 offset:49152
  v_exp_f32 v40, v40
  v_mul_f32 v41, v41, v101
  v_mul_f32 v42, v42, v102
  v_exp_f32 v41, v41
  v_mul_f32 v43, v43, v103
  v_mfma_f32_32x32x16_bf16 v[112:127], v[180:183], v[84:87], v[112:127]
  ds_read_b128 v[52:55], v5 offset:50176
  v_fma_f32 v40, v40, v17, v17
  v_exp_f32 v42, v42
  s_add_u32 s46, s91, 20480
  buffer_load_dwordx4 a[160:163], v2, s[48:51], s46 offen offset:0 sc1
  s_waitcnt vmcnt(5)
  s_add_u32 s8, s97, 114688
  buffer_load_dwordx4 v[36:39], v2, s[48:51], s8 offen sc1
  buffer_load_dwordx4 v[36:39], v2, s[48:51], s8 offen offset:1024 sc1
  s_waitcnt lgkmcnt(2)
  v_mfma_f32_32x32x16_bf16 v[112:127], v[184:187], v[88:91], v[112:127]
  ds_read_b128 v[56:59], v5 offset:51200
  v_fma_f32 v41, v41, v17, v17
  v_fma_f32 v42, v42, v17, v17
  v_exp_f32 v43, v43
  v_mul_f32 v24, v104, v104
  v_fma_f32 v43, v43, v17, v17
  v_mfma_f32_32x32x16_bf16 v[112:127], v[188:191], v[92:95], v[112:127]
  ds_read_b128 v[60:63], v5 offset:52224
  v_rcp_f32 v40, v40
  v_mul_f32 v25, v105, v105
  v_mul_f32 v40, v40, v100
  v_rcp_f32 v41, v41
  v_mul_f32 v26, v106, v106
  s_waitcnt lgkmcnt(2)
  v_mfma_f32_32x32x16_bf16 v[112:127], v[192:195], v[48:51], v[112:127]
  ds_read_b128 v[80:83], v5 offset:53248
  v_mul_f32 v41, v41, v101
  s_add_u32 s47, s92, 20480
  buffer_load_dwordx4 a[164:167], v2, s[48:51], s47 offen offset:0 sc1
  v_rcp_f32 v42, v42
  v_cvt_pk_bf16_f32 v30, v40, v41
  v_mul_f32 v42, v42, v102
  v_mfma_f32_32x32x16_bf16 v[112:127], v[196:199], v[52:55], v[112:127]
  ds_read_b128 v[84:87], v5 offset:54272
  v_rcp_f32 v43, v43
  v_mul_f32 v27, v107, v107
  v_mul_f32 v43, v43, v103
  v_cvt_pk_bf16_f32 v31, v42, v43
  s_add_u32 s10, s97, 229376
  buffer_store_dwordx4 v[28:31], v2, s[48:51], s10 offen sc1
  s_waitcnt lgkmcnt(2)
  v_mfma_f32_32x32x16_bf16 v[112:127], v[200:203], v[56:59], v[112:127]
  ds_read_b128 v[88:91], v5 offset:55296
  v_fma_f32 v24, v24, v21, v20
  v_fma_f32 v25, v25, v21, v20
  v_fma_f32 v26, v26, v21, v20
  buffer_load_dwordx4 a[168:171], v2, s[48:51], s46 offen offset:1024 sc1
  v_mfma_f32_32x32x16_bf16 v[112:127], v[204:207], v[60:63], v[112:127]
  ds_read_b128 v[92:95], v5 offset:56320
  v_fma_f32 v27, v27, v21, v20
  v_mul_f32 v24, v24, v104
  v_exp_f32 v24, v24
  v_mul_f32 v25, v25, v105
  v_mul_f32 v26, v26, v106
  s_waitcnt lgkmcnt(2)
  v_mfma_f32_32x32x16_bf16 v[112:127], v[208:211], v[80:83], v[112:127]
  ds_read_b128 v[48:51], v5 offset:57344
  v_exp_f32 v25, v25
  v_mul_f32 v27, v27, v107
  v_fma_f32 v24, v24, v17, v17
  v_exp_f32 v26, v26
  v_fma_f32 v25, v25, v17, v17
  v_mfma_f32_32x32x16_bf16 v[112:127], v[212:215], v[84:87], v[112:127]
  ds_read_b128 v[52:55], v5 offset:58368
  v_fma_f32 v26, v26, v17, v17
  buffer_load_dwordx4 a[172:175], v2, s[48:51], s47 offen offset:1024 sc1
  v_exp_f32 v27, v27
  v_mul_f32 v40, v108, v108
  v_fma_f32 v27, v27, v17, v17
  s_waitcnt lgkmcnt(2)
  v_mfma_f32_32x32x16_bf16 v[112:127], v[216:219], v[88:91], v[112:127]
  ds_read_b128 v[56:59], v5 offset:59392
  v_rcp_f32 v24, v24
  v_mul_f32 v41, v109, v109
  v_mul_f32 v24, v24, v104
  v_rcp_f32 v25, v25
  v_mfma_f32_32x32x16_bf16 v[112:127], v[220:223], v[92:95], v[112:127]
  ds_read_b128 v[60:63], v5 offset:60416
  v_mul_f32 v42, v110, v110
  v_mul_f32 v25, v25, v105
  v_rcp_f32 v26, v26
  v_cvt_pk_bf16_f32 v32, v24, v25
  buffer_load_dwordx4 a[176:179], v2, s[48:51], s46 offen offset:2048 sc1
  s_waitcnt lgkmcnt(2)
  v_mfma_f32_32x32x16_bf16 v[112:127], v[224:227], v[48:51], v[112:127]
  ds_read_b128 v[80:83], v5 offset:61440
  v_mul_f32 v26, v26, v106
  v_rcp_f32 v27, v27
  v_mul_f32 v43, v111, v111
  v_mul_f32 v27, v27, v107
  v_cvt_pk_bf16_f32 v33, v26, v27
  v_mfma_f32_32x32x16_bf16 v[112:127], v[228:231], v[52:55], v[112:127]
  ds_read_b128 v[84:87], v5 offset:62464
  v_fma_f32 v40, v40, v21, v20
  v_fma_f32 v41, v41, v21, v20
  v_fma_f32 v42, v42, v21, v20
  v_fma_f32 v43, v43, v21, v20
  v_mul_f32 v40, v40, v108
  s_waitcnt lgkmcnt(2)
  v_mfma_f32_32x32x16_bf16 v[112:127], v[232:235], v[56:59], v[112:127]
  ds_read_b128 v[88:91], v5 offset:63488
  v_exp_f32 v40, v40
  buffer_load_dwordx4 a[180:183], v2, s[48:51], s47 offen offset:2048 sc1
  v_mul_f32 v41, v41, v109
  v_mul_f32 v42, v42, v110
  v_mfma_f32_32x32x16_bf16 v[112:127], v[236:239], v[60:63], v[112:127]
  ds_read_b128 v[92:95], v5 offset:64512
  v_exp_f32 v41, v41
  v_mul_f32 v43, v43, v111
  v_fma_f32 v40, v40, v17, v17
  v_exp_f32 v42, v42
  v_fma_f32 v41, v41, v17, v17
  s_waitcnt lgkmcnt(2)
  v_mfma_f32_32x32x16_bf16 v[112:127], v[240:243], v[80:83], v[112:127]
  v_fma_f32 v42, v42, v17, v17
  v_exp_f32 v43, v43
  v_rcp_f32 v40, v40
  v_fma_f32 v43, v43, v17, v17
  buffer_load_dwordx4 a[184:187], v2, s[48:51], s46 offen offset:3072 sc1
  v_mfma_f32_32x32x16_bf16 v[112:127], v[244:247], v[84:87], v[112:127]
  v_mul_f32 v40, v40, v108
  v_rcp_f32 v41, v41
  v_rcp_f32 v42, v42
  v_mul_f32 v41, v41, v109
  v_mul_f32 v42, v42, v110
  s_waitcnt lgkmcnt(0)
  v_mfma_f32_32x32x16_bf16 v[112:127], v[248:251], v[88:91], v[112:127]
  v_rcp_f32 v43, v43
  v_cvt_pk_bf16_f32 v34, v40, v41
  v_mul_f32 v43, v43, v111
  v_cvt_pk_bf16_f32 v35, v42, v43
  buffer_store_dwordx4 v[32:35], v2, s[48:51], s10 offen offset:1024 sc1
  v_mfma_f32_32x32x16_bf16 v[112:127], v[252:255], v[92:95], v[112:127]
  v_mfma_f32_32x32x16_bf16 v[112:127], v[8:11], v[44:47], v[112:127]
  v_rcp_f32 v24, v19
s_nop 0
  v_mul_f32 v20, 0xc0135761, v24
  v_mul_f32 v24, v24, v24
  v_mul_f32 v24, 0x3d372713, v24
  v_mul_f32 v21, v24, v20
s_nop 5
  v_pk_mul_f32 v[24:25], v[112:113], v[112:113]
  v_pk_mul_f32 v[26:27], v[114:115], v[114:115]
  v_pk_fma_f32 v[24:25], v[24:25], v[20:21], v[20:21] op_sel:[0,1,0] op_sel_hi:[1,1,0]
  v_pk_fma_f32 v[26:27], v[26:27], v[20:21], v[20:21] op_sel:[0,1,0] op_sel_hi:[1,1,0]
  v_pk_mul_f32 v[24:25], v[24:25], v[112:113]
  v_pk_mul_f32 v[26:27], v[26:27], v[114:115]
  v_exp_f32 v24, v24
  v_exp_f32 v25, v25
  v_exp_f32 v26, v26
  v_exp_f32 v27, v27
  v_pk_fma_f32 v[24:25], v[24:25], v[18:19], v[18:19] op_sel:[0,1,1] op_sel_hi:[1,1,1]
  v_pk_fma_f32 v[26:27], v[26:27], v[18:19], v[18:19] op_sel:[0,1,1] op_sel_hi:[1,1,1]
  v_rcp_f32 v24, v24
  v_rcp_f32 v25, v25
  v_rcp_f32 v26, v26
  v_rcp_f32 v27, v27
  v_pk_mul_f32 v[24:25], v[24:25], v[112:113]
  v_pk_mul_f32 v[26:27], v[26:27], v[114:115]
  v_cvt_pk_bf16_f32 v28, v24, v25
  v_cvt_pk_bf16_f32 v29, v26, v27
  v_pk_mul_f32 v[24:25], v[116:117], v[116:117]
  v_pk_mul_f32 v[26:27], v[118:119], v[118:119]
  v_pk_fma_f32 v[24:25], v[24:25], v[20:21], v[20:21] op_sel:[0,1,0] op_sel_hi:[1,1,0]
  v_pk_fma_f32 v[26:27], v[26:27], v[20:21], v[20:21] op_sel:[0,1,0] op_sel_hi:[1,1,0]
  v_pk_mul_f32 v[24:25], v[24:25], v[116:117]
  v_pk_mul_f32 v[26:27], v[26:27], v[118:119]
  v_exp_f32 v24, v24
  v_exp_f32 v25, v25
  v_exp_f32 v26, v26
  v_exp_f32 v27, v27
  v_pk_fma_f32 v[24:25], v[24:25], v[18:19], v[18:19] op_sel:[0,1,1] op_sel_hi:[1,1,1]
  v_pk_fma_f32 v[26:27], v[26:27], v[18:19], v[18:19] op_sel:[0,1,1] op_sel_hi:[1,1,1]
  v_rcp_f32 v24, v24
  v_rcp_f32 v25, v25
  v_rcp_f32 v26, v26
  v_rcp_f32 v27, v27
  v_pk_mul_f32 v[24:25], v[24:25], v[116:117]
  v_pk_mul_f32 v[26:27], v[26:27], v[118:119]
  v_cvt_pk_bf16_f32 v30, v24, v25
  v_cvt_pk_bf16_f32 v31, v26, v27
  s_add_u32 s10, s97, 344064
  buffer_store_dwordx4 v[28:31], v2, s[48:51], s10 offen sc1
  v_pk_mul_f32 v[24:25], v[120:121], v[120:121]
  v_pk_mul_f32 v[26:27], v[122:123], v[122:123]
  v_pk_fma_f32 v[24:25], v[24:25], v[20:21], v[20:21] op_sel:[0,1,0] op_sel_hi:[1,1,0]
  v_pk_fma_f32 v[26:27], v[26:27], v[20:21], v[20:21] op_sel:[0,1,0] op_sel_hi:[1,1,0]
  v_pk_mul_f32 v[24:25], v[24:25], v[120:121]
  v_pk_mul_f32 v[26:27], v[26:27], v[122:123]
  v_exp_f32 v24, v24
  v_exp_f32 v25, v25
  v_exp_f32 v26, v26
  v_exp_f32 v27, v27
  v_pk_fma_f32 v[24:25], v[24:25], v[18:19], v[18:19] op_sel:[0,1,1] op_sel_hi:[1,1,1]
  v_pk_fma_f32 v[26:27], v[26:27], v[18:19], v[18:19] op_sel:[0,1,1] op_sel_hi:[1,1,1]
  v_rcp_f32 v24, v24
  v_rcp_f32 v25, v25
  v_rcp_f32 v26, v26
  v_rcp_f32 v27, v27
  v_pk_mul_f32 v[24:25], v[24:25], v[120:121]
  v_pk_mul_f32 v[26:27], v[26:27], v[122:123]
  v_cvt_pk_bf16_f32 v32, v24, v25
  v_cvt_pk_bf16_f32 v33, v26, v27
  v_pk_mul_f32 v[24:25], v[124:125], v[124:125]
  v_pk_mul_f32 v[26:27], v[126:127], v[126:127]
  v_pk_fma_f32 v[24:25], v[24:25], v[20:21], v[20:21] op_sel:[0,1,0] op_sel_hi:[1,1,0]
  v_pk_fma_f32 v[26:27], v[26:27], v[20:21], v[20:21] op_sel:[0,1,0] op_sel_hi:[1,1,0]
  v_pk_mul_f32 v[24:25], v[24:25], v[124:125]
  v_pk_mul_f32 v[26:27], v[26:27], v[126:127]
  v_exp_f32 v24, v24
  v_exp_f32 v25, v25
  v_exp_f32 v26, v26
  v_exp_f32 v27, v27
  v_pk_fma_f32 v[24:25], v[24:25], v[18:19], v[18:19] op_sel:[0,1,1] op_sel_hi:[1,1,1]
  v_pk_fma_f32 v[26:27], v[26:27], v[18:19], v[18:19] op_sel:[0,1,1] op_sel_hi:[1,1,1]
  v_rcp_f32 v24, v24
  v_rcp_f32 v25, v25
  v_rcp_f32 v26, v26
  v_rcp_f32 v27, v27
  v_pk_mul_f32 v[24:25], v[24:25], v[124:125]
  v_pk_mul_f32 v[26:27], v[26:27], v[126:127]
  v_cvt_pk_bf16_f32 v34, v24, v25
  v_cvt_pk_bf16_f32 v35, v26, v27
  buffer_store_dwordx4 v[32:35], v2, s[48:51], s10 offen offset:1024 sc1
  s_waitcnt vmcnt(2)
  s_add_u32 s8, s97, 229376
  buffer_load_dwordx4 v[36:39], v2, s[48:51], s8 offen sc1
  buffer_load_dwordx4 v[36:39], v2, s[48:51], s8 offen offset:1024 sc1
  v_mov_b32 v44, 3
  s_waitcnt vmcnt(2)
  s_barrier
  s_cmp_lg_u32 s3, 0
  s_cbranch_scc1 Q7
  s_mov_b64 exec, 1
  buffer_store_dword v44, off, s[48:51], s99 sc1
  s_mov_b64 exec, -1
Q7:
  s_waitcnt vmcnt(2)
  s_add_u32 s8, s97, 344064
  buffer_load_dwordx4 v[36:39], v2, s[48:51], s8 offen sc1
  buffer_load_dwordx4 v[36:39], v2, s[48:51], s8 offen offset:1024 sc1
  buffer_load_dwordx4 a[188:191], v2, s[48:51], s47 offen offset:3072 sc1
  s_add_u32 s46, s91, 24576
  buffer_load_dwordx4 a[192:195], v2, s[48:51], s46 offen offset:0 sc1
  s_add_u32 s47, s92, 24576
  buffer_load_dwordx4 a[196:199], v2, s[48:51], s47 offen offset:0 sc1
  buffer_load_dwordx4 a[200:203], v2, s[48:51], s46 offen offset:1024 sc1
  buffer_load_dwordx4 a[204:207], v2, s[48:51], s47 offen offset:1024 sc1
  buffer_load_dwordx4 a[208:211], v2, s[48:51], s46 offen offset:2048 sc1
  buffer_load_dwordx4 a[212:215], v2, s[48:51], s47 offen offset:2048 sc1
  buffer_load_dwordx4 a[216:219], v2, s[48:51], s46 offen offset:3072 sc1
  buffer_load_dwordx4 a[220:223], v2, s[48:51], s47 offen offset:3072 sc1
  s_branch L_g3done
L_g3skip:
  buffer_load_dwordx4 a[72:75], v2, s[48:51], s46 offen offset:1024 sc1
  buffer_load_dwordx4 a[76:79], v2, s[48:51], s47 offen offset:1024 sc1
  buffer_load_dwordx4 a[80:83], v2, s[48:51], s46 offen offset:2048 sc1
  buffer_load_dwordx4 a[84:87], v2, s[48:51], s47 offen offset:2048 sc1
  buffer_load_dwordx4 a[88:91], v2, s[48:51], s46 offen offset:3072 sc1
  buffer_load_dwordx4 a[92:95], v2, s[48:51], s47 offen offset:3072 sc1
  s_add_u32 s46, s91, 12288
  buffer_load_dwordx4 a[96:99], v2, s[48:51], s46 offen offset:0 sc1
  s_add_u32 s47, s92, 12288
  buffer_load_dwordx4 a[100:103], v2, s[48:51], s47 offen offset:0 sc1
  buffer_load_dwordx4 a[104:107], v2, s[48:51], s46 offen offset:1024 sc1
  buffer_load_dwordx4 a[108:111], v2, s[48:51], s47 offen offset:1024 sc1
  buffer_load_dwordx4 a[112:115], v2, s[48:51], s46 offen offset:2048 sc1
  buffer_load_dwordx4 a[116:119], v2, s[48:51], s47 offen offset:2048 sc1
  buffer_load_dwordx4 a[120:123], v2, s[48:51], s46 offen offset:3072 sc1
  buffer_load_dwordx4 a[124:127], v2, s[48:51], s47 offen offset:3072 sc1
  s_add_u32 s46, s91, 16384
  buffer_load_dwordx4 a[128:131], v2, s[48:51], s46 offen offset:0 sc1
  s_add_u32 s47, s92, 16384
  buffer_load_dwordx4 a[132:135], v2, s[48:51], s47 offen offset:0 sc1
  buffer_load_dwordx4 a[136:139], v2, s[48:51], s46 offen offset:1024 sc1
  buffer_load_dwordx4 a[140:143], v2, s[48:51], s47 offen offset:1024 sc1
  buffer_load_dwordx4 a[144:147], v2, s[48:51], s46 offen offset:2048 sc1
  buffer_load_dwordx4 a[148:151], v2, s[48:51], s47 offen offset:2048 sc1
  buffer_load_dwordx4 a[152:155], v2, s[48:51], s46 offen offset:3072 sc1
  buffer_load_dwordx4 a[156:159], v2, s[48:51], s47 offen offset:3072 sc1
  s_add_u32 s46, s91, 20480
  buffer_load_dwordx4 a[160:163], v2, s[48:51], s46 offen offset:0 sc1
  s_add_u32 s47, s92, 20480
  buffer_load_dwordx4 a[164:167], v2, s[48:51], s47 offen offset:0 sc1
  buffer_load_dwordx4 a[168:171], v2, s[48:51], s46 offen offset:1024 sc1
  buffer_load_dwordx4 a[172:175], v2, s[48:51], s47 offen offset:1024 sc1
  buffer_load_dwordx4 a[176:179], v2, s[48:51], s46 offen offset:2048 sc1
  buffer_load_dwordx4 a[180:183], v2, s[48:51], s47 offen offset:2048 sc1
  buffer_load_dwordx4 a[184:187], v2, s[48:51], s46 offen offset:3072 sc1
  buffer_load_dwordx4 a[188:191], v2, s[48:51], s47 offen offset:3072 sc1
  s_add_u32 s46, s91, 24576
  buffer_load_dwordx4 a[192:195], v2, s[48:51], s46 offen offset:0 sc1
  s_add_u32 s47, s92, 24576
  buffer_load_dwordx4 a[196:199], v2, s[48:51], s47 offen offset:0 sc1
  buffer_load_dwordx4 a[200:203], v2, s[48:51], s46 offen offset:1024 sc1
  buffer_load_dwordx4 a[204:207], v2, s[48:51], s47 offen offset:1024 sc1
  buffer_load_dwordx4 a[208:211], v2, s[48:51], s46 offen offset:2048 sc1
  buffer_load_dwordx4 a[212:215], v2, s[48:51], s47 offen offset:2048 sc1
  buffer_load_dwordx4 a[216:219], v2, s[48:51], s46 offen offset:3072 sc1
  buffer_load_dwordx4 a[220:223], v2, s[48:51], s47 offen offset:3072 sc1
L_g3done:
s_nop 11
  s_lshl_b32 s8, s75, 1
  s_lshr_b32 s9, s3, 1
  s_add_u32 s8, s8, s9
  s_lshl_b32 s10, s76, 1
  s_and_b32 s11, s3, 1
  s_add_u32 s10, s10, s11
  s_lshl_b32 s12, s8, 15
  s_lshl_b32 s13, s10, 11
  s_add_u32 s13, s12, s13
  s_add_u32 s14, s13, 7340032
  s_add_u32 s13, s13, 5242880
  s_lshl_b32 s10, s10, 6
  s_add_u32 s96, s12, s10
  buffer_load_dwordx4 v[8:11], v2, s[48:51], s13 offen sc1
  buffer_load_dwordx4 v[12:15], v2, s[48:51], s13 offen offset:1024 sc1
  buffer_load_dwordx4 v[16:19], v2, s[48:51], s14 offen sc1
  buffer_load_dwordx4 v[20:23], v2, s[48:51], s14 offen offset:1024 sc1
  s_mul_i32 s8, s75, 229376
  s_mul_i32 s9, s33, 28672
  s_add_u32 s8, s8, s9
  s_add_u32 s12, s8, 9437184
  s_add_u32 s14, s12, 114688
  s_cmp_lt_u32 s3, 2
  s_cselect_b32 s8, s12, s14
  s_cselect_b32 s14, s14, s12
  s_mov_b32 s12, s8
  v_and_b32 v4, 31, v1
  v_lshlrev_b32 v4, 10, v4
  v_lshrrev_b32 v5, 5, v1
  v_lshl_add_u32 v4, v5, 4, v4
  s_lshl_b32 s9, s3, 12
  s_lshl_b32 s8, s3, 14
  v_add_u32 v40, s9, v2
  v_add_u32 v41, s8, v2
  s_cmp_lg_u32 s3, 0
  s_cbranch_scc1 P8_done
  v_min_u32 v6, 13, v1
  s_and_b32 s8, s73, 1
  s_lshl_b32 s8, s8, 4
  v_add_u32 v6, s8, v6
  v_lshlrev_b32 v6, 3, v6
  s_lshr_b32 s8, s73, 1
  v_add_u32 v6, s8, v6
  v_lshlrev_b32 v6, 7, v6
  s_mov_b32 s6, 30000
P8_loop:
  buffer_load_dword v5, v6, s[48:51], 0 offen sc1
  s_sub_u32 s6, s6, 1
  s_cbranch_scc1 P8_done
  s_waitcnt vmcnt(0)
  v_cmp_gt_u32 vcc, 3, v5
s_nop 4
  s_cbranch_vccnz P8_loop
P8_done:
  s_barrier
  s_waitcnt vmcnt(0)
  s_add_u32 s10, s12, 0
  buffer_load_dwordx4 v[112:115], v2, s[48:51], s10 offen offset:0 sc1
  s_add_u32 s11, s14, 0
  buffer_load_dwordx4 v[116:119], v2, s[48:51], s11 offen offset:0 sc1
  buffer_load_dwordx4 v[120:123], v2, s[48:51], s10 offen offset:1024 sc1
  buffer_load_dwordx4 v[124:127], v2, s[48:51], s11 offen offset:1024 sc1
  buffer_load_dwordx4 v[128:131], v2, s[48:51], s10 offen offset:2048 sc1
  buffer_load_dwordx4 v[132:135], v2, s[48:51], s11 offen offset:2048 sc1
  buffer_load_dwordx4 v[136:139], v2, s[48:51], s10 offen offset:3072 sc1
  buffer_load_dwordx4 v[140:143], v2, s[48:51], s11 offen offset:3072 sc1
  s_waitcnt vmcnt(7)
  v_mfma_f32_32x32x16_bf16 v[48:63], a[0:3], v[112:115], 0
  v_mfma_f32_32x32x16_bf16 v[64:79], a[4:7], v[112:115], 0
  s_add_u32 s10, s12, 4096
  buffer_load_dwordx4 v[112:115], v2, s[48:51], s10 offen offset:0 sc1
  s_waitcnt vmcnt(7)
  v_mfma_f32_32x32x16_bf16 v[80:95], a[0:3], v[116:119], 0
  v_mfma_f32_32x32x16_bf16 v[96:111], a[4:7], v[116:119], 0
  s_add_u32 s11, s14, 4096
  buffer_load_dwordx4 v[116:119], v2, s[48:51], s11 offen offset:0 sc1
  s_waitcnt vmcnt(7)
  v_mfma_f32_32x32x16_bf16 v[48:63], a[8:11], v[120:123], v[48:63]
  v_mfma_f32_32x32x16_bf16 v[64:79], a[12:15], v[120:123], v[64:79]
  buffer_load_dwordx4 v[120:123], v2, s[48:51], s10 offen offset:1024 sc1
  s_waitcnt vmcnt(7)
  v_mfma_f32_32x32x16_bf16 v[80:95], a[8:11], v[124:127], v[80:95]
  v_mfma_f32_32x32x16_bf16 v[96:111], a[12:15], v[124:127], v[96:111]
  buffer_load_dwordx4 v[124:127], v2, s[48:51], s11 offen offset:1024 sc1
  s_waitcnt vmcnt(7)
  v_mfma_f32_32x32x16_bf16 v[48:63], a[16:19], v[128:131], v[48:63]
  v_mfma_f32_32x32x16_bf16 v[64:79], a[20:23], v[128:131], v[64:79]
  buffer_load_dwordx4 v[128:131], v2, s[48:51], s10 offen offset:2048 sc1
  s_waitcnt vmcnt(7)
  v_mfma_f32_32x32x16_bf16 v[80:95], a[16:19], v[132:135], v[80:95]
  v_mfma_f32_32x32x16_bf16 v[96:111], a[20:23], v[132:135], v[96:111]
  buffer_load_dwordx4 v[132:135], v2, s[48:51], s11 offen offset:2048 sc1
  s_waitcnt vmcnt(7)
  v_mfma_f32_32x32x16_bf16 v[48:63], a[24:27], v[136:139], v[48:63]
  v_mfma_f32_32x32x16_bf16 v[64:79], a[28:31], v[136:139], v[64:79]
  buffer_load_dwordx4 v[136:139], v2, s[48:51], s10 offen offset:3072 sc1
  s_waitcnt vmcnt(7)
  v_mfma_f32_32x32x16_bf16 v[80:95], a[24:27], v[140:143], v[80:95]
  v_mfma_f32_32x32x16_bf16 v[96:111], a[28:31], v[140:143], v[96:111]
  buffer_load_dwordx4 v[140:143], v2, s[48:51], s11 offen offset:3072 sc1
  s_waitcnt vmcnt(7)
  v_mfma_f32_32x32x16_bf16 v[48:63], a[32:35], v[112:115], v[48:63]
  v_mfma_f32_32x32x16_bf16 v[64:79], a[36:39], v[112:115], v[64:79]
  s_add_u32 s10, s12, 8192
  buffer_load_dwordx4 v[112:115], v2, s[48:51], s10 offen offset:0 sc1
  s_waitcnt vmcnt(7)
  v_mfma_f32_32x32x16_bf16 v[80:95], a[32:35], v[116:119], v[80:95]
  v_mfma_f32_32x32x16_bf16 v[96:111], a[36:39], v[116:119], v[96:111]
  s_add_u32 s11, s14, 8192
  buffer_load_dwordx4 v[116:119], v2, s[48:51], s11 offen offset:0 sc1
  s_waitcnt vmcnt(7)
  v_mfma_f32_32x32x16_bf16 v[48:63], a[40:43], v[120:123], v[48:63]
  v_mfma_f32_32x32x16_bf16 v[64:79], a[44:47], v[120:123], v[64:79]
  buffer_load_dwordx4 v[120:123], v2, s[48:51], s10 offen offset:1024 sc1
  s_waitcnt vmcnt(7)
  v_mfma_f32_32x32x16_bf16 v[80:95], a[40:43], v[124:127], v[80:95]
  v_mfma_f32_32x32x16_bf16 v[96:111], a[44:47], v[124:127], v[96:111]
  buffer_load_dwordx4 v[124:127], v2, s[48:51], s11 offen offset:1024 sc1
  s_waitcnt vmcnt(7)
  v_mfma_f32_32x32x16_bf16 v[48:63], a[48:51], v[128:131], v[48:63]
  v_mfma_f32_32x32x16_bf16 v[64:79], a[52:55], v[128:131], v[64:79]
  buffer_load_dwordx4 v[128:131], v2, s[48:51], s10 offen offset:2048 sc1
  s_waitcnt vmcnt(7)
  v_mfma_f32_32x32x16_bf16 v[80:95], a[48:51], v[132:135], v[80:95]
  v_mfma_f32_32x32x16_bf16 v[96:111], a[52:55], v[132:135], v[96:111]
  buffer_load_dwordx4 v[132:135], v2, s[48:51], s11 offen offset:2048 sc1
  s_waitcnt vmcnt(7)
  v_mfma_f32_32x32x16_bf16 v[48:63], a[56:59], v[136:139], v[48:63]
  v_mfma_f32_32x32x16_bf16 v[64:79], a[60:63], v[136:139], v[64:79]
  buffer_load_dwordx4 v[136:139], v2, s[48:51], s10 offen offset:3072 sc1
  s_waitcnt vmcnt(7)
  v_mfma_f32_32x32x16_bf16 v[80:95], a[56:59], v[140:143], v[80:95]
  v_mfma_f32_32x32x16_bf16 v[96:111], a[60:63], v[140:143], v[96:111]
  buffer_load_dwordx4 v[140:143], v2, s[48:51], s11 offen offset:3072 sc1
  s_waitcnt vmcnt(7)
  v_mfma_f32_32x32x16_bf16 v[48:63], a[64:67], v[112:115], v[48:63]
  v_mfma_f32_32x32x16_bf16 v[64:79], a[68:71], v[112:115], v[64:79]
  s_add_u32 s10, s12, 12288
  buffer_load_dwordx4 v[112:115], v2, s[48:51], s10 offen offset:0 sc1
  s_waitcnt vmcnt(7)
  v_mfma_f32_32x32x16_bf16 v[80:95], a[64:67], v[116:119], v[80:95]
  v_mfma_f32_32x32x16_bf16 v[96:111], a[68:71], v[116:119], v[96:111]
  s_add_u32 s11, s14, 12288
  buffer_load_dwordx4 v[116:119], v2, s[48:51], s11 offen offset:0 sc1
  s_waitcnt vmcnt(7)
  v_mfma_f32_32x32x16_bf16 v[48:63], a[72:75], v[120:123], v[48:63]
  v_mfma_f32_32x32x16_bf16 v[64:79], a[76:79], v[120:123], v[64:79]
  buffer_load_dwordx4 v[120:123], v2, s[48:51], s10 offen offset:1024 sc1
  s_waitcnt vmcnt(7)
  v_mfma_f32_32x32x16_bf16 v[80:95], a[72:75], v[124:127], v[80:95]
  v_mfma_f32_32x32x16_bf16 v[96:111], a[76:79], v[124:127], v[96:111]
  buffer_load_dwordx4 v[124:127], v2, s[48:51], s11 offen offset:1024 sc1
  s_waitcnt vmcnt(7)
  v_mfma_f32_32x32x16_bf16 v[48:63], a[80:83], v[128:131], v[48:63]
  v_mfma_f32_32x32x16_bf16 v[64:79], a[84:87], v[128:131], v[64:79]
  buffer_load_dwordx4 v[128:131], v2, s[48:51], s10 offen offset:2048 sc1
  s_waitcnt vmcnt(7)
  v_mfma_f32_32x32x16_bf16 v[80:95], a[80:83], v[132:135], v[80:95]
  v_mfma_f32_32x32x16_bf16 v[96:111], a[84:87], v[132:135], v[96:111]
  buffer_load_dwordx4 v[132:135], v2, s[48:51], s11 offen offset:2048 sc1
  s_waitcnt vmcnt(7)
  v_mfma_f32_32x32x16_bf16 v[48:63], a[88:91], v[136:139], v[48:63]
  v_mfma_f32_32x32x16_bf16 v[64:79], a[92:95], v[136:139], v[64:79]
  buffer_load_dwordx4 v[136:139], v2, s[48:51], s10 offen offset:3072 sc1
  s_waitcnt vmcnt(7)
  v_mfma_f32_32x32x16_bf16 v[80:95], a[88:91], v[140:143], v[80:95]
  v_mfma_f32_32x32x16_bf16 v[96:111], a[92:95], v[140:143], v[96:111]
  buffer_load_dwordx4 v[140:143], v2, s[48:51], s11 offen offset:3072 sc1
  s_waitcnt vmcnt(7)
  v_mfma_f32_32x32x16_bf16 v[48:63], a[96:99], v[112:115], v[48:63]
  v_mfma_f32_32x32x16_bf16 v[64:79], a[100:103], v[112:115], v[64:79]
  s_add_u32 s10, s12, 16384
  buffer_load_dwordx4 v[112:115], v2, s[48:51], s10 offen offset:0 sc1
  s_waitcnt vmcnt(7)
  v_mfma_f32_32x32x16_bf16 v[80:95], a[96:99], v[116:119], v[80:95]
  v_mfma_f32_32x32x16_bf16 v[96:111], a[100:103], v[116:119], v[96:111]
  s_add_u32 s11, s14, 16384
  buffer_load_dwordx4 v[116:119], v2, s[48:51], s11 offen offset:0 sc1
  s_waitcnt vmcnt(7)
  v_mfma_f32_32x32x16_bf16 v[48:63], a[104:107], v[120:123], v[48:63]
  v_mfma_f32_32x32x16_bf16 v[64:79], a[108:111], v[120:123], v[64:79]
  buffer_load_dwordx4 v[120:123], v2, s[48:51], s10 offen offset:1024 sc1
  s_waitcnt vmcnt(7)
  v_mfma_f32_32x32x16_bf16 v[80:95], a[104:107], v[124:127], v[80:95]
  v_mfma_f32_32x32x16_bf16 v[96:111], a[108:111], v[124:127], v[96:111]
  buffer_load_dwordx4 v[124:127], v2, s[48:51], s11 offen offset:1024 sc1
  s_waitcnt vmcnt(7)
  v_mfma_f32_32x32x16_bf16 v[48:63], a[112:115], v[128:131], v[48:63]
  v_mfma_f32_32x32x16_bf16 v[64:79], a[116:119], v[128:131], v[64:79]
  buffer_load_dwordx4 v[128:131], v2, s[48:51], s10 offen offset:2048 sc1
  s_waitcnt vmcnt(7)
  v_mfma_f32_32x32x16_bf16 v[80:95], a[112:115], v[132:135], v[80:95]
  v_mfma_f32_32x32x16_bf16 v[96:111], a[116:119], v[132:135], v[96:111]
  buffer_load_dwordx4 v[132:135], v2, s[48:51], s11 offen offset:2048 sc1
  s_waitcnt vmcnt(7)
  v_mfma_f32_32x32x16_bf16 v[48:63], a[120:123], v[136:139], v[48:63]
  v_mfma_f32_32x32x16_bf16 v[64:79], a[124:127], v[136:139], v[64:79]
  buffer_load_dwordx4 v[136:139], v2, s[48:51], s10 offen offset:3072 sc1
  s_waitcnt vmcnt(7)
  v_mfma_f32_32x32x16_bf16 v[80:95], a[120:123], v[140:143], v[80:95]
  v_mfma_f32_32x32x16_bf16 v[96:111], a[124:127], v[140:143], v[96:111]
  buffer_load_dwordx4 v[140:143], v2, s[48:51], s11 offen offset:3072 sc1
  s_waitcnt vmcnt(7)
  v_mfma_f32_32x32x16_bf16 v[48:63], a[128:131], v[112:115], v[48:63]
  v_mfma_f32_32x32x16_bf16 v[64:79], a[132:135], v[112:115], v[64:79]
  s_add_u32 s10, s12, 20480
  buffer_load_dwordx4 v[112:115], v2, s[48:51], s10 offen offset:0 sc1
  s_waitcnt vmcnt(7)
  v_mfma_f32_32x32x16_bf16 v[80:95], a[128:131], v[116:119], v[80:95]
  v_mfma_f32_32x32x16_bf16 v[96:111], a[132:135], v[116:119], v[96:111]
  s_add_u32 s11, s14, 20480
  buffer_load_dwordx4 v[116:119], v2, s[48:51], s11 offen offset:0 sc1
  s_waitcnt vmcnt(7)
  v_mfma_f32_32x32x16_bf16 v[48:63], a[136:139], v[120:123], v[48:63]
  v_mfma_f32_32x32x16_bf16 v[64:79], a[140:143], v[120:123], v[64:79]
  buffer_load_dwordx4 v[120:123], v2, s[48:51], s10 offen offset:1024 sc1
  s_waitcnt vmcnt(7)
  v_mfma_f32_32x32x16_bf16 v[80:95], a[136:139], v[124:127], v[80:95]
  v_mfma_f32_32x32x16_bf16 v[96:111], a[140:143], v[124:127], v[96:111]
  buffer_load_dwordx4 v[124:127], v2, s[48:51], s11 offen offset:1024 sc1
  s_waitcnt vmcnt(7)
  v_mfma_f32_32x32x16_bf16 v[48:63], a[144:147], v[128:131], v[48:63]
  v_mfma_f32_32x32x16_bf16 v[64:79], a[148:151], v[128:131], v[64:79]
  buffer_load_dwordx4 v[128:131], v2, s[48:51], s10 offen offset:2048 sc1
  s_waitcnt vmcnt(7)
  v_mfma_f32_32x32x16_bf16 v[80:95], a[144:147], v[132:135], v[80:95]
  v_mfma_f32_32x32x16_bf16 v[96:111], a[148:151], v[132:135], v[96:111]
  buffer_load_dwordx4 v[132:135], v2, s[48:51], s11 offen offset:2048 sc1
  s_waitcnt vmcnt(7)
  v_mfma_f32_32x32x16_bf16 v[48:63], a[152:155], v[136:139], v[48:63]
  v_mfma_f32_32x32x16_bf16 v[64:79], a[156:159], v[136:139], v[64:79]
  buffer_load_dwordx4 v[136:139], v2, s[48:51], s10 offen offset:3072 sc1
  s_waitcnt vmcnt(7)
  v_mfma_f32_32x32x16_bf16 v[80:95], a[152:155], v[140:143], v[80:95]
  v_mfma_f32_32x32x16_bf16 v[96:111], a[156:159], v[140:143], v[96:111]
  buffer_load_dwordx4 v[140:143], v2, s[48:51], s11 offen offset:3072 sc1
  s_waitcnt vmcnt(7)
  v_mfma_f32_32x32x16_bf16 v[48:63], a[160:163], v[112:115], v[48:63]
  v_mfma_f32_32x32x16_bf16 v[64:79], a[164:167], v[112:115], v[64:79]
  s_add_u32 s10, s12, 24576
  buffer_load_dwordx4 v[112:115], v2, s[48:51], s10 offen offset:0 sc1
  s_waitcnt vmcnt(7)
  v_mfma_f32_32x32x16_bf16 v[80:95], a[160:163], v[116:119], v[80:95]
  v_mfma_f32_32x32x16_bf16 v[96:111], a[164:167], v[116:119], v[96:111]
  s_add_u32 s11, s14, 24576
  buffer_load_dwordx4 v[116:119], v2, s[48:51], s11 offen offset:0 sc1
  s_waitcnt vmcnt(7)
  v_mfma_f32_32x32x16_bf16 v[48:63], a[168:171], v[120:123], v[48:63]
  v_mfma_f32_32x32x16_bf16 v[64:79], a[172:175], v[120:123], v[64:79]
  buffer_load_dwordx4 v[120:123], v2, s[48:51], s10 offen offset:1024 sc1
  s_waitcnt vmcnt(7)
  v_mfma_f32_32x32x16_bf16 v[80:95], a[168:171], v[124:127], v[80:95]
  v_mfma_f32_32x32x16_bf16 v[96:111], a[172:175], v[124:127], v[96:111]
  buffer_load_dwordx4 v[124:127], v2, s[48:51], s11 offen offset:1024 sc1
  s_waitcnt vmcnt(7)
  v_mfma_f32_32x32x16_bf16 v[48:63], a[176:179], v[128:131], v[48:63]
  v_mfma_f32_32x32x16_bf16 v[64:79], a[180:183], v[128:131], v[64:79]
  buffer_load_dwordx4 v[128:131], v2, s[48:51], s10 offen offset:2048 sc1
  s_waitcnt vmcnt(7)
  v_mfma_f32_32x32x16_bf16 v[80:95], a[176:179], v[132:135], v[80:95]
  v_mfma_f32_32x32x16_bf16 v[96:111], a[180:183], v[132:135], v[96:111]
  buffer_load_dwordx4 v[132:135], v2, s[48:51], s11 offen offset:2048 sc1
  s_waitcnt vmcnt(7)
  v_mfma_f32_32x32x16_bf16 v[48:63], a[184:187], v[136:139], v[48:63]
  v_mfma_f32_32x32x16_bf16 v[64:79], a[188:191], v[136:139], v[64:79]
  buffer_load_dwordx4 v[136:139], v2, s[48:51], s10 offen offset:3072 sc1
  s_waitcnt vmcnt(7)
  v_mfma_f32_32x32x16_bf16 v[80:95], a[184:187], v[140:143], v[80:95]
  v_mfma_f32_32x32x16_bf16 v[96:111], a[188:191], v[140:143], v[96:111]
  buffer_load_dwordx4 v[140:143], v2, s[48:51], s11 offen offset:3072 sc1
  s_waitcnt vmcnt(7)
  v_mfma_f32_32x32x16_bf16 v[48:63], a[192:195], v[112:115], v[48:63]
  v_mfma_f32_32x32x16_bf16 v[64:79], a[196:199], v[112:115], v[64:79]
  s_waitcnt vmcnt(6)
  v_mfma_f32_32x32x16_bf16 v[80:95], a[192:195], v[116:119], v[80:95]
  v_mfma_f32_32x32x16_bf16 v[96:111], a[196:199], v[116:119], v[96:111]
  s_waitcnt vmcnt(5)
  v_mfma_f32_32x32x16_bf16 v[48:63], a[200:203], v[120:123], v[48:63]
  v_mfma_f32_32x32x16_bf16 v[64:79], a[204:207], v[120:123], v[64:79]
  s_waitcnt vmcnt(4)
  v_mfma_f32_32x32x16_bf16 v[80:95], a[200:203], v[124:127], v[80:95]
  v_mfma_f32_32x32x16_bf16 v[96:111], a[204:207], v[124:127], v[96:111]
  s_waitcnt vmcnt(3)
  v_mfma_f32_32x32x16_bf16 v[48:63], a[208:211], v[128:131], v[48:63]
  v_mfma_f32_32x32x16_bf16 v[64:79], a[212:215], v[128:131], v[64:79]
  s_waitcnt vmcnt(2)
  v_mfma_f32_32x32x16_bf16 v[80:95], a[208:211], v[132:135], v[80:95]
  v_mfma_f32_32x32x16_bf16 v[96:111], a[212:215], v[132:135], v[96:111]
  s_waitcnt vmcnt(1)
  v_mfma_f32_32x32x16_bf16 v[48:63], a[216:219], v[136:139], v[48:63]
  v_mfma_f32_32x32x16_bf16 v[64:79], a[220:223], v[136:139], v[64:79]
  s_waitcnt vmcnt(0)
  v_mfma_f32_32x32x16_bf16 v[80:95], a[216:219], v[140:143], v[80:95]
  v_mfma_f32_32x32x16_bf16 v[96:111], a[220:223], v[140:143], v[96:111]
  s_xor_b32 s8, s3, 1
  s_lshl_b32 s8, s8, 14
  v_add_u32 v40, s8, v2
s_nop 5
  ds_write_b128 v40, v[64:67] offset:4096
  ds_write_b128 v40, v[68:71] offset:5120
  ds_write_b128 v40, v[72:75] offset:6144
  ds_write_b128 v40, v[76:79] offset:7168
  s_xor_b32 s8, s3, 2
  s_lshl_b32 s8, s8, 14
  v_add_u32 v40, s8, v2
  ds_write_b128 v40, v[80:83] offset:8192
  ds_write_b128 v40, v[84:87] offset:9216
  ds_write_b128 v40, v[88:91] offset:10240
  ds_write_b128 v40, v[92:95] offset:11264
  s_xor_b32 s8, s3, 3
  s_lshl_b32 s8, s8, 14
  v_add_u32 v40, s8, v2
  ds_write_b128 v40, v[96:99] offset:12288
  ds_write_b128 v40, v[100:103] offset:13312
  ds_write_b128 v40, v[104:107] offset:14336
  ds_write_b128 v40, v[108:111] offset:15360
  v_lshlrev_b32 v112, 16, v16
  v_and_b32 v113, s69, v16
  v_lshlrev_b32 v128, 16, v8
  v_and_b32 v129, s69, v8
  v_lshlrev_b32 v114, 16, v17
  v_and_b32 v115, s69, v17
  v_lshlrev_b32 v130, 16, v9
  v_and_b32 v131, s69, v9
  v_lshlrev_b32 v116, 16, v18
  v_and_b32 v117, s69, v18
  v_lshlrev_b32 v132, 16, v10
  v_and_b32 v133, s69, v10
  v_lshlrev_b32 v118, 16, v19
  v_and_b32 v119, s69, v19
  v_lshlrev_b32 v134, 16, v11
  v_and_b32 v135, s69, v11
  v_lshlrev_b32 v120, 16, v20
  v_and_b32 v121, s69, v20
  v_lshlrev_b32 v136, 16, v12
  v_and_b32 v137, s69, v12
  v_lshlrev_b32 v122, 16, v21
  v_and_b32 v123, s69, v21
  v_lshlrev_b32 v138, 16, v13
  v_and_b32 v139, s69, v13
  v_lshlrev_b32 v124, 16, v22
  v_and_b32 v125, s69, v22
  v_lshlrev_b32 v140, 16, v14
  v_and_b32 v141, s69, v14
  v_lshlrev_b32 v126, 16, v23
  v_and_b32 v127, s69, v23
  v_lshlrev_b32 v142, 16, v15
  v_and_b32 v143, s69, v15
  s_waitcnt lgkmcnt(0)
  s_barrier
  ds_read_b128 v[64:67], v41 offset:4096
  ds_read_b128 v[68:71], v41 offset:5120
  ds_read_b128 v[72:75], v41 offset:6144
  ds_read_b128 v[76:79], v41 offset:7168
  ds_read_b128 v[80:83], v41 offset:8192
  ds_read_b128 v[84:87], v41 offset:9216
  ds_read_b128 v[88:91], v41 offset:10240
  ds_read_b128 v[92:95], v41 offset:11264
  ds_read_b128 v[96:99], v41 offset:12288
  ds_read_b128 v[100:103], v41 offset:13312
  ds_read_b128 v[104:107], v41 offset:14336
  ds_read_b128 v[108:111], v41 offset:15360
  s_waitcnt lgkmcnt(11)
  v_pk_add_f32 v[48:49], v[48:49], v[64:65]
  v_pk_add_f32 v[50:51], v[50:51], v[66:67]
  s_waitcnt lgkmcnt(10)
  v_pk_add_f32 v[52:53], v[52:53], v[68:69]
  v_pk_add_f32 v[54:55], v[54:55], v[70:71]
  s_waitcnt lgkmcnt(9)
  v_pk_add_f32 v[56:57], v[56:57], v[72:73]
  v_pk_add_f32 v[58:59], v[58:59], v[74:75]
  s_waitcnt lgkmcnt(8)
  v_pk_add_f32 v[60:61], v[60:61], v[76:77]
  v_pk_add_f32 v[62:63], v[62:63], v[78:79]
  s_waitcnt lgkmcnt(7)
  v_pk_add_f32 v[48:49], v[48:49], v[80:81]
  v_pk_add_f32 v[50:51], v[50:51], v[82:83]
  s_waitcnt lgkmcnt(6)
  v_pk_add_f32 v[52:53], v[52:53], v[84:85]
  v_pk_add_f32 v[54:55], v[54:55], v[86:87]
  s_waitcnt lgkmcnt(5)
  v_pk_add_f32 v[56:57], v[56:57], v[88:89]
  v_pk_add_f32 v[58:59], v[58:59], v[90:91]
  s_waitcnt lgkmcnt(4)
  v_pk_add_f32 v[60:61], v[60:61], v[92:93]
  v_pk_add_f32 v[62:63], v[62:63], v[94:95]
  s_waitcnt lgkmcnt(3)
  v_pk_add_f32 v[48:49], v[48:49], v[96:97]
  v_pk_add_f32 v[50:51], v[50:51], v[98:99]
  s_waitcnt lgkmcnt(2)
  v_pk_add_f32 v[52:53], v[52:53], v[100:101]
  v_pk_add_f32 v[54:55], v[54:55], v[102:103]
  s_waitcnt lgkmcnt(1)
  v_pk_add_f32 v[56:57], v[56:57], v[104:105]
  v_pk_add_f32 v[58:59], v[58:59], v[106:107]
  s_waitcnt lgkmcnt(0)
  v_pk_add_f32 v[60:61], v[60:61], v[108:109]
  v_pk_add_f32 v[62:63], v[62:63], v[110:111]
  v_cvt_pk_bf16_f32 v24, v48, v49
  v_cvt_pk_bf16_f32 v25, v50, v51
  v_cvt_pk_bf16_f32 v26, v52, v53
  v_cvt_pk_bf16_f32 v27, v54, v55
  v_cvt_pk_bf16_f32 v28, v56, v57
  v_cvt_pk_bf16_f32 v29, v58, v59
  v_cvt_pk_bf16_f32 v30, v60, v61
  v_cvt_pk_bf16_f32 v31, v62, v63
  v_lshlrev_b32 v48, 16, v24
  v_and_b32 v49, s69, v24
  v_lshlrev_b32 v50, 16, v25
  v_and_b32 v51, s69, v25
  v_lshlrev_b32 v52, 16, v26
  v_and_b32 v53, s69, v26
  v_lshlrev_b32 v54, 16, v27
  v_and_b32 v55, s69, v27
  v_lshlrev_b32 v56, 16, v28
  v_and_b32 v57, s69, v28
  v_lshlrev_b32 v58, 16, v29
  v_and_b32 v59, s69, v29
  v_lshlrev_b32 v60, 16, v30
  v_and_b32 v61, s69, v30
  v_lshlrev_b32 v62, 16, v31
  v_and_b32 v63, s69, v31
  v_pk_add_f32 v[48:49], v[48:49], v[112:113]
  v_pk_add_f32 v[50:51], v[50:51], v[114:115]
  v_pk_add_f32 v[52:53], v[52:53], v[116:117]
  v_pk_add_f32 v[54:55], v[54:55], v[118:119]
  v_pk_add_f32 v[56:57], v[56:57], v[120:121]
  v_pk_add_f32 v[58:59], v[58:59], v[122:123]
  v_pk_add_f32 v[60:61], v[60:61], v[124:125]
  v_pk_add_f32 v[62:63], v[62:63], v[126:127]
  v_cvt_pk_bf16_f32 v24, v48, v49
  v_cvt_pk_bf16_f32 v25, v50, v51
  v_cvt_pk_bf16_f32 v26, v52, v53
  v_cvt_pk_bf16_f32 v27, v54, v55
  v_cvt_pk_bf16_f32 v28, v56, v57
  v_cvt_pk_bf16_f32 v29, v58, v59
  v_cvt_pk_bf16_f32 v30, v60, v61
  v_cvt_pk_bf16_f32 v31, v62, v63
  v_lshlrev_b32 v48, 16, v24
  v_and_b32 v49, s69, v24
  v_lshlrev_b32 v50, 16, v25
  v_and_b32 v51, s69, v25
  v_lshlrev_b32 v52, 16, v26
  v_and_b32 v53, s69, v26
  v_lshlrev_b32 v54, 16, v27
  v_and_b32 v55, s69, v27
  v_lshlrev_b32 v56, 16, v28
  v_and_b32 v57, s69, v28
  v_lshlrev_b32 v58, 16, v29
  v_and_b32 v59, s69, v29
  v_lshlrev_b32 v60, 16, v30
  v_and_b32 v61, s69, v30
  v_lshlrev_b32 v62, 16, v31
  v_and_b32 v63, s69, v31
  v_pk_add_f32 v[48:49], v[48:49], v[128:129]
  v_pk_add_f32 v[50:51], v[50:51], v[130:131]
  v_pk_add_f32 v[52:53], v[52:53], v[132:133]
  v_pk_add_f32 v[54:55], v[54:55], v[134:135]
  v_pk_add_f32 v[56:57], v[56:57], v[136:137]
  v_pk_add_f32 v[58:59], v[58:59], v[138:139]
  v_pk_add_f32 v[60:61], v[60:61], v[140:141]
  v_pk_add_f32 v[62:63], v[62:63], v[142:143]
  v_cvt_pk_bf16_f32 v24, v48, v49
  v_cvt_pk_bf16_f32 v25, v50, v51
  v_cvt_pk_bf16_f32 v26, v52, v53
  v_cvt_pk_bf16_f32 v27, v54, v55
  v_cvt_pk_bf16_f32 v28, v56, v57
  v_cvt_pk_bf16_f32 v29, v58, v59
  v_cvt_pk_bf16_f32 v30, v60, v61
  v_cvt_pk_bf16_f32 v31, v62, v63
  v_permlane32_swap_b32 v24, v26
  v_permlane32_swap_b32 v25, v27
  v_permlane32_swap_b32 v28, v30
  v_permlane32_swap_b32 v29, v31
  buffer_store_dwordx4 v[24:27], v4, s[56:59], s96 offen offset:0
  buffer_store_dwordx4 v[28:31], v4, s[56:59], s96 offen offset:32
  s_endpgm
.section .rodata,"a"
.p2align 6
.amdhsa_kernel sequential_preLN__ssm_conv_s4d__mixer_s_mlp__prompt_kernel
  .amdhsa_next_free_vgpr 512
  .amdhsa_next_free_sgpr 102
  .amdhsa_accum_offset 256
  .amdhsa_group_segment_fixed_size 0
  .amdhsa_kernarg_size 120
  .amdhsa_user_sgpr_count 2
  .amdhsa_user_sgpr_kernarg_segment_ptr 1
  .amdhsa_system_sgpr_workgroup_id_x 1
.end_amdhsa_kernel
```
